```python
import torch

def _softmax(x, axis=-1):
    return torch.softmax(x, dim=axis)
def _gelu(x):
    return torch.nn.functional.gelu(x, approximate="tanh")
def _silu(x):
    return torch.nn.functional.silu(x)
def _sigmoid(x):
    return torch.sigmoid(x)
def _layernorm(x, axis=-1, eps=1e-5):
    m = x.mean(dim=axis, keepdim=True)
    v = x.var(dim=axis, keepdim=True, unbiased=False)
    return (x - m) / torch.sqrt(v + eps)
def _scatter_add(tgt, idx, src, axis=0):
    return tgt.clone().index_add_(axis, idx, src)
def _segment_sum(src, seg, n):
    out = torch.zeros((n,) + src.shape[1:], dtype=src.dtype)
    return out.index_add_(0, seg, src)
def _pad(x, pw):
    flat = tuple(v for pair in reversed(pw) for v in pair)
    return torch.nn.functional.pad(x, flat)

kernel_name = 'recurrent_scan__ssm_conv_s4__dense_activation_gelu__prompt'

def setup_inputs():

    _w = (lambda a: (lambda t: t.to(torch.bfloat16) if t.is_floating_point() else t)(torch.as_tensor(a)))
    def _A_setup():
        B, L, D, N = 1, 2048, 640, 192
        A_re = -(lambda _x: torch.exp(torch.as_tensor(_x)))((lambda *s: torch.randn(*s, dtype=torch.bfloat16) * 3.2)(D, N))
        A_im = torch.pi * (lambda *s: torch.randn(*s, dtype=torch.bfloat16) * 0.2)(D, N)
        B_re = (lambda *s: torch.randn(*s, dtype=torch.bfloat16) * 0.2)(D, N)
        B_im = (lambda *s: torch.randn(*s, dtype=torch.bfloat16) * 0.2)(D, N)
        C_re = (lambda *s: torch.randn(*s, dtype=torch.bfloat16) * 0.2)(D, N)
        C_im = (lambda *s: torch.randn(*s, dtype=torch.bfloat16) * 0.2)(D, N)
        log_dt = (lambda *s: torch.randn(*s, dtype=torch.bfloat16) * 0.2)(D) * 0.5 - 4.0
        Dskip = (lambda *s: torch.randn(*s, dtype=torch.bfloat16) * 0.2)(D)
        return {
            "u": _w((lambda *s: torch.randn(*s, dtype=torch.bfloat16) * 0.05)(B, L, D)),
            "A_re": _w(A_re),
            "A_im": _w(A_im),
            "B_re": _w(B_re),
            "B_im": _w(B_im),
            "C_re": _w(C_re),
            "C_im": _w(C_im),
            "log_dt": _w(log_dt),
            "Dskip": _w(Dskip),
        }
    _A_in = _A_setup()

    def _B_setup():
        B, S, D, F = 1, 2048, 640, 1536
        return {
            "x": _w((lambda *s: torch.randn(*s, dtype=torch.bfloat16) * 0.05)(B, S, D)),
            "w1": _w((lambda *s: torch.randn(*s, dtype=torch.bfloat16) * 0.8)(D, F) * (D ** -0.5)),
            "b1": _w((lambda *s: torch.randn(*s, dtype=torch.bfloat16) * 0.1)(F) * 0.01),
            "w2": _w((lambda *s: torch.randn(*s, dtype=torch.bfloat16) * 0.1)(F, D) * (F ** -0.5)),
            "b2": _w((lambda *s: torch.randn(*s, dtype=torch.bfloat16) * 0.1)(D) * 0.01),
        }
    _B_in = _B_setup()

    return {
        "A_u": _A_in["u"],
        "A_A_re": _A_in["A_re"],
        "A_A_im": _A_in["A_im"],
        "A_B_re": _A_in["B_re"],
        "A_B_im": _A_in["B_im"],
        "A_C_re": _A_in["C_re"],
        "A_C_im": _A_in["C_im"],
        "A_log_dt": _A_in["log_dt"],
        "A_Dskip": _A_in["Dskip"],
        "B_x": _B_in["x"],
        "B_w1": _B_in["w1"],
        "B_b1": _B_in["b1"],
        "B_w2": _B_in["w2"],
        "B_b2": _B_in["b2"],
    }

def reference(A_u, A_A_re, A_A_im, A_B_re, A_B_im, A_C_re, A_C_im, A_log_dt, A_Dskip, B_x, B_w1, B_b1, B_w2, B_b2):
    def _A_ref(u, A_re, A_im, B_re, B_im, C_re, C_im, log_dt, Dskip):
        Bsz, L, D = u.shape
        dt = torch.exp(log_dt)[:, None]
        A = A_re + 1j * A_im
        Bc = B_re + 1j * B_im
        Cc = C_re + 1j * C_im
        logdA = dt * A
        dB = dt * Bc
        l = (lambda x, dt: x.to(dt))(torch.arange(L), A_re.dtype)
        P = torch.exp(logdA[:, :, None] * l[None, None, :])
        K = torch.einsum("dn,dnl,dn->dl", Cc, P, dB).real
        L2 = 2 * L
        Kp = _pad(K, ((0, 0), (0, L)))
        up = (lambda x, *d: x.permute(*d))(u, 0, 2, 1)
        up = _pad(up, ((0, 0), (0, 0), (0, L)))
        Kf = (lambda x, axes=(-2,-1): torch.fft.rfft2(x.float(), dim=axes))(Kp[:, None, :], axes=(-2, -1))
        Uf = (lambda x, axes=(-2,-1): torch.fft.rfft2(x.float(), dim=axes))(up[:, :, None, :], axes=(-2, -1))
        Yf = Uf * Kf[None, :, :, :]
        y = (lambda x, s, axes=(-2,-1): torch.fft.irfft2(x, s=s, dim=axes).to(torch.bfloat16))(Yf, (1, L2), axes=(-2, -1))[:, :, 0, :L]
        y = (lambda x, *d: x.permute(*d))(y, 0, 2, 1) + u * Dskip[None, None, :]
        return y

    def _B_ref(x, w1, b1, w2, b2):
        h = torch.einsum("bsd,df->bsf", x, w1) + b1
        h = _gelu(h)
        return torch.einsum("bsf,fd->bsd", h, w2) + b2

    x = A_u
    xn = _layernorm(x, axis=-1)
    s = _A_ref(xn, A_A_re, A_A_im, A_B_re, A_B_im, A_C_re, A_C_im, A_log_dt, A_Dskip)
    g = _silu(_B_ref(xn, B_w1, B_b1, B_w2, B_b2))
    return x + s * g
```

```asm
; @launch grid=(256,1,1) block=(512,1,1) lds=163840
.amdgcn_target "amdgcn-amd-amdhsa--gfx950"
.text
.globl recurrent_scan__ssm_conv_s4__dense_activation_gelu__prompt_kernel
.p2align 8
.type recurrent_scan__ssm_conv_s4__dense_activation_gelu__prompt_kernel,@function
recurrent_scan__ssm_conv_s4__dense_activation_gelu__prompt_kernel:
    s_cmp_ge_u32 s2, 256
    s_cbranch_scc1 k_end
    s_load_dwordx2 s[4:5], s[0:1], 0
    s_getpc_b64 s[8:9]
k_pcref:
    s_mov_b32 s10, code_end-k_pcref
    s_mov_b32 s11, 0x20000
    s_lshr_b32 s3, s2, 3
    s_lshl_b32 s3, s3, 10
    v_lshlrev_b32 v2, 1, v0
    v_and_b32 v2, 0x380, v2
    buffer_load_dword v254, v2, s[8:11], s3 offen
    s_load_dwordx16 s[48:63], s[0:1], 8
    s_load_dwordx8 s[84:91], s[0:1], 80
    s_load_dwordx4 s[92:95], s[0:1], 112
    s_load_dwordx2 s[6:7], s[0:1], 128
    v_lshrrev_b32 v2, 6, v0
    v_and_b32 v1, 63, v0
    v_readfirstlane_b32 s32, v2
    v_mov_b32 v8, 0
    v_mov_b32 v9, 0
    v_mov_b32 v10, 0
    v_mov_b32 v11, 0
    v_mov_b32 v15, 31232
    ds_write_b128 v15, v[8:11]
    ds_write_b128 v15, v[8:11] offset:16
    ds_write_b128 v15, v[8:11] offset:32
    ds_write_b128 v15, v[8:11] offset:48
    s_bfe_u32 s33, s2, 0x20001
    s_lshl_b32 s33, s33, 3
    s_lshr_b32 s35, s2, 5
    s_add_u32 s33, s33, s35
    s_and_b32 s34, s2, 1
    s_lshl_b32 s34, s34, 2
    s_bfe_u32 s36, s2, 0x20003
    s_add_u32 s34, s34, s36
    s_lshl_b32 s40, s36, 1
    s_add_u32 s40, s40, s35
    s_and_b32 s45, s36, 2
    s_lshl_b32 s45, s45, 1
    s_add_u32 s45, s45, s35
    s_and_b32 s82, s36, 1
    s_and_b32 s40, s40, 0
    s_and_b32 s45, s45, 7
    s_mul_i32 s45, s45, 5
    s_lshr_b32 s45, s45, 2
    s_and_b32 s39, s32, 3
    s_mov_b32 s44, 0xffff0000
    s_mov_b32 s41, 0
    s_cmp_ge_u32 s32, 4
    s_cbranch_scc1 k_h
    v_lshrrev_b32 v2, 3, v1
    v_and_b32 v3, 7, v1
    v_lshrrev_b32 v12, 4, v1
    v_xor_b32 v3, v3, v12
    v_mul_u32_u24 v4, 1280, v2
    v_lshl_add_u32 v4, v3, 4, v4
    v_xor_b32 v3, 64, v4
    v_add_u32 v3, 10240, v3
    s_cmp_eq_u32 s82, 0
    s_cselect_b64 vcc, -1, 0
    s_lshl_b32 s42, s33, 2
    s_add_u32 s42, s42, s39
    s_mul_i32 s42, s42, 20480
    v_cndmask_b32 v13, v3, v4, vcc
    v_cndmask_b32 v14, v4, v3, vcc
    s_lshl_b32 s66, s45, 7
    s_add_u32 s66, s66, s42
    s_add_u32 s47, s42, 1280
    s_add_u32 s67, s66, 128
    s_cmp_eq_u32 s67, s47
    s_cselect_b32 s67, s42, s67
    s_add_u32 s68, s67, 128
    s_cmp_eq_u32 s68, s47
    s_cselect_b32 s68, s42, s68
    s_add_u32 s69, s68, 128
    s_cmp_eq_u32 s69, s47
    s_cselect_b32 s69, s42, s69
    s_add_u32 s70, s69, 128
    s_cmp_eq_u32 s70, s47
    s_cselect_b32 s70, s42, s70
    s_mul_i32 s43, s39, 20480
    s_lshl_b32 s35, s82, 10
    s_add_u32 s43, s43, s35
    s_add_u32 s43, s43, 81920
    s_xor_b32 s76, s43, 1024
    s_waitcnt lgkmcnt(0)
    s_barrier
    s_mov_b32 s8, s4
    s_mov_b32 s9, s5
    s_mov_b32 s10, 0x280000
    s_mov_b32 s11, 0x20000
    s_add_u32 m0, s43, 0
    s_nop 0
    buffer_load_dwordx4 v13, s[8:11], s66 offen lds
    s_add_u32 m0, s43, 2048
    s_nop 0
    buffer_load_dwordx4 v13, s[8:11], s67 offen lds
    s_add_u32 m0, s43, 4096
    s_nop 0
    buffer_load_dwordx4 v13, s[8:11], s68 offen lds
    s_add_u32 m0, s43, 6144
    s_nop 0
    buffer_load_dwordx4 v13, s[8:11], s69 offen lds
    s_add_u32 m0, s43, 8192
    s_nop 0
    buffer_load_dwordx4 v13, s[8:11], s70 offen lds
    s_add_u32 s71, s70, 128
    s_cmp_eq_u32 s71, s47
    s_cselect_b32 s71, s42, s71
    s_add_u32 s72, s71, 128
    s_cmp_eq_u32 s72, s47
    s_cselect_b32 s72, s42, s72
    s_add_u32 s73, s72, 128
    s_cmp_eq_u32 s73, s47
    s_cselect_b32 s73, s42, s73
    s_add_u32 s74, s73, 128
    s_cmp_eq_u32 s74, s47
    s_cselect_b32 s74, s42, s74
    s_add_u32 s75, s74, 128
    s_cmp_eq_u32 s75, s47
    s_cselect_b32 s75, s42, s75
    s_add_u32 m0, s43, 10240
    s_nop 0
    buffer_load_dwordx4 v13, s[8:11], s71 offen lds
    s_branch k_g2
k_x0:
    s_waitcnt lgkmcnt(0)
    s_barrier
    s_branch k_x
k_h:
    s_setprio 3
    s_mul_i32 s38, s39, 8704
    s_mul_i32 s37, s2, 3
    s_add_u32 s37, s37, s39
    s_mul_i32 s47, s37, 384
    s_lshl_b32 s36, s37, 1
    v_lshlrev_b32 v12, 1, v1
    s_add_u32 s35, s2, 384
    s_cmp_eq_u32 s39, 3
    s_cselect_b32 s46, s35, s37
    v_lshlrev_b32 v13, 2, v1
    s_mov_b32 s22, 0x3c000
    s_mov_b32 s23, 0x20000
    s_mov_b32 s26, 0x3c000
    s_mov_b32 s27, 0x20000
    s_cbranch_scc1 k_x0
    s_cmp_ge_u32 s37, 640
    s_cbranch_scc1 k_x0
    s_waitcnt lgkmcnt(0)
    s_mov_b32 s12, s60
    s_mov_b32 s13, s61
    s_mov_b32 s14, 0x500
    s_mov_b32 s15, 0x20000
    buffer_load_ushort v154, v8, s[12:15], s36 offen
    s_mov_b64 s[24:25], s[48:49]
    buffer_load_dword v142, v13, s[24:27], s47 offen
    buffer_load_ushort v148, v12, s[24:27], s47 offen offset:256
    s_mov_b64 s[20:21], s[50:51]
    buffer_load_dword v143, v13, s[20:23], s47 offen
    buffer_load_ushort v149, v12, s[20:23], s47 offen offset:256
    s_mov_b64 s[24:25], s[52:53]
    buffer_load_dword v144, v13, s[24:27], s47 offen
    buffer_load_ushort v150, v12, s[24:27], s47 offen offset:256
    s_mov_b64 s[20:21], s[54:55]
    buffer_load_dword v145, v13, s[20:23], s47 offen
    buffer_load_ushort v151, v12, s[20:23], s47 offen offset:256
    s_mov_b64 s[24:25], s[56:57]
    buffer_load_dword v146, v13, s[24:27], s47 offen
    buffer_load_ushort v152, v12, s[24:27], s47 offen offset:256
    s_mov_b64 s[20:21], s[58:59]
    buffer_load_dword v147, v13, s[20:23], s47 offen
    buffer_load_ushort v153, v12, s[20:23], s47 offen offset:256
    s_barrier
    s_mov_b32 s16, s62
    s_mov_b32 s17, s63
    s_mov_b32 s18, 0x500
    s_mov_b32 s19, 0x20000
    buffer_load_ushort v155, v8, s[16:19], s36 offen
    s_setprio 1
    s_add_u32 s28, s6, 0xf00000
    s_addc_u32 s29, s7, 0
    s_mov_b32 s30, 0x40000
    s_mov_b32 s31, 0x20000
    s_mov_b32 s96, s94
    s_mov_b32 s97, s95
    s_mov_b32 s98, 0x100
    s_mov_b32 s99, 0x20000
    s_add_u32 s20, s6, 0x600000
    s_addc_u32 s21, s7, 0
    s_mov_b32 s22, 0x294000
    s_mov_b32 s23, 0x20000
    s_add_u32 s16, s6, 0xa00000
    s_addc_u32 s17, s7, 0
    s_mov_b32 s18, 0x294000
    s_mov_b32 s19, 0x20000
    s_mul_i32 s54, s39, 12288
    s_add_u32 s54, s54, 32768
    v_and_b32 v4, 31, v1
    v_lshrrev_b32 v5, 5, v1
    v_mul_u32_u24 v6, 272, v4
    v_lshl_add_u32 v6, v5, 4, v6
    v_add_u32 v6, s38, v6
    v_lshlrev_b32 v240, 4, v4
    v_lshl_add_u32 v240, v5, 3, v240
    v_lshlrev_b32 v241, 3, v4
    v_add_u32 v241, 512, v241
    v_add_u32 v242, 4, v241
    v_lshlrev_b32 v251, 2, v4
    v_add_u32 v2, 768, v251
    v_add_u32 v3, 896, v251
    v_cmp_eq_u32 vcc, 0, v5
    v_lshlrev_b32 v243, 1, v4
    v_lshl_add_u32 v243, v5, 8, v243
    v_cndmask_b32 v241, v2, v241, vcc
    v_cndmask_b32 v242, v3, v242, vcc
    v_add_u32 v240, s38, v240
    v_add_u32 v241, s38, v241
    v_add_u32 v242, s38, v242
    v_add_u32 v243, s38, v243
    v_lshlrev_b32 v2, 3, v1
    v_add_u32 v244, s38, v2
    v_lshlrev_b32 v3, 2, v1
    v_add_u32 v245, s38, v3
    v_add_u32 v246, 512, v245
    v_and_b32 v3, 1, v1
    v_lshlrev_b32 v3, 4, v3
    v_add_u32 v247, s38, v3
    s_add_u32 s36, s38, 2016
    v_sub_u32 v248, s36, v2
    v_sub_u32 v249, v248, v2
    v_lshlrev_b32 v3, 5, v1
    v_sub_u32 v250, s36, v3
    v_lshlrev_b32 v8, 4, v1
    v_add_u32 v252, s54, v8
    v_min_u32 v3, 29, v1
    v_lshlrev_b32 v3, 4, v3
    v_add_u32 v253, s54, v3
    v_mov_b32 v7, s38
    v_and_b32 v4, 15, v1
    v_lshrrev_b32 v5, 4, v1
    v_lshlrev_b32 v2, 3, v5
    v_sub_u32 v2, v2, v4
    v_add_u32 v2, 15, v2
    v_and_b32 v3, 1, v2
    v_mul_u32_u24 v3, 4162, v3
    v_lshl_add_u32 v2, v2, 1, v3
    v_add_u32 v10, s38, v2
    v_add_u32 v11, 1024, v10
    v_add_u32 v12, 2048, v10
    v_add_u32 v13, 3072, v10
    v_lshlrev_b32 v9, 5, v4
    v_lshl_add_u32 v9, v5, 4, v9
    v_add_u32 v9, s54, v9
    v_mov_b32 v64, 0
    v_mov_b32 v65, 0
    v_mov_b32 v66, 0
    v_mov_b32 v67, 0
    v_mov_b32 v68, 0
    v_mov_b32 v69, 0
    v_mov_b32 v70, 0
    v_mov_b32 v71, 0
    v_mov_b32 v72, 0
    v_mov_b32 v73, 0
    v_mov_b32 v74, 0
    v_mov_b32 v75, 0
    v_mov_b32 v76, 0
    v_mov_b32 v77, 0
    v_mov_b32 v78, 0
    v_mov_b32 v79, 0
    v_mov_b32 v36, 0
    v_mov_b32 v37, 0
    v_mov_b32 v38, 0
    v_mov_b32 v39, 0
    v_mov_b32 v5, 0x3f80
    s_mov_b32 s56, 0x01000100
    s_mov_b32 s57, 0x03020302
    s_mov_b32 s58, 0x05040504
    s_mov_b32 s59, 0x01000302
    s_mov_b32 s60, 0x03020504
    s_mov_b32 s61, 0x05040706
    s_mul_i32 s52, s37, 205
    s_lshr_b32 s52, s52, 14
    s_mov_b32 s83, 229376
    s_mul_i32 s50, s2, 3
    s_add_u32 s50, s50, 0
    s_min_u32 s50, s50, 639
    s_mul_i32 s50, s50, 205
    s_lshr_b32 s50, s50, 14
    s_mul_i32 s53, s50, 1747680
    s_lshr_b32 s53, s53, 16
    s_sub_u32 s53, s2, s53
    s_lshl_b32 s50, s50, 5
    s_add_u32 s50, s50, s53
    s_lshl_b32 s50, s50, 2
    s_mul_i32 s51, s2, 3
    s_add_u32 s51, s51, 2
    s_min_u32 s51, s51, 639
    s_mul_i32 s51, s51, 205
    s_lshr_b32 s51, s51, 14
    s_mul_i32 s53, s51, 1747680
    s_lshr_b32 s53, s53, 16
    s_sub_u32 s53, s2, s53
    s_lshl_b32 s51, s51, 5
    s_add_u32 s51, s51, s53
    s_lshl_b32 s51, s51, 2
    v_cmp_gt_u32 vcc, 32, v1
    v_and_b32 v251, 31, v1
    v_lshlrev_b32 v251, 10, v251
    v_mov_b32 v2, s50
    v_mov_b32 v3, s51
    v_cndmask_b32 v2, v3, v2, vcc
    v_add3_u32 v251, v251, v2, s83
    s_cmp_eq_u32 s2, 213
    s_cselect_b32 s51, 1, 3
    s_and_b32 s52, s52, 1
    s_lshl_b32 s53, s2, 1
    s_add_u32 s52, s52, s53
    s_lshl_b32 s52, s52, 7
    s_add_u32 s52, s52, 135168
    s_mul_i32 s53, s37, 4224
    s_mov_b32 s46, 0
    s_mov_b32 m0, s38
    s_waitcnt vmcnt(1)
    v_lshlrev_b32 v2, 16, v154
    v_mul_f32 v2, 0x3fb8aa3b, v2
    v_lshlrev_b32 v136, 16, v142
    v_lshlrev_b32 v137, 16, v143
    v_lshlrev_b32 v138, 16, v144
    v_lshlrev_b32 v139, 16, v145
    v_lshlrev_b32 v140, 16, v146
    v_lshlrev_b32 v141, 16, v147
    v_exp_f32 v2, v2
    v_and_b32 v142, s44, v142
    v_and_b32 v143, s44, v143
    v_and_b32 v144, s44, v144
    v_and_b32 v145, s44, v145
    v_and_b32 v146, s44, v146
    v_and_b32 v147, s44, v147
    v_lshlrev_b32 v148, 16, v148
    v_lshlrev_b32 v149, 16, v149
    v_lshlrev_b32 v150, 16, v150
    v_lshlrev_b32 v151, 16, v151
    v_lshlrev_b32 v152, 16, v152
    v_lshlrev_b32 v153, 16, v153
    v_cvt_pk_bf16_f32 v2, v2, v2
    s_nop 0
    v_lshlrev_b32 v2, 16, v2
    v_mul_f32 v136, v136, v2
    v_mul_f32 v142, v142, v2
    v_mul_f32 v148, v148, v2
    v_mul_f32 v137, v137, v2
    v_mul_f32 v143, v143, v2
    v_mul_f32 v149, v149, v2
    v_mul_f32 v138, v138, v2
    v_mul_f32 v144, v144, v2
    v_mul_f32 v150, v150, v2
    v_mul_f32 v139, v139, v2
    v_mul_f32 v145, v145, v2
    v_mul_f32 v151, v151, v2
    v_mul_f32 v160, v140, v138
    v_mul_f32 v171, v146, v144
    v_mul_f32 v182, v152, v150
    v_mul_f32 v161, v141, v138
    v_mul_f32 v172, v147, v144
    v_mul_f32 v183, v153, v150
    v_fma_f32 v160, -v141, v139, v160
    v_fma_f32 v171, -v147, v145, v171
    v_fma_f32 v182, -v153, v151, v182
    v_fmac_f32 v161, v140, v139
    v_fmac_f32 v172, v146, v145
    v_fmac_f32 v183, v152, v151
    v_mul_f32 v40, 0x3fb8aa3b, v136
    v_mul_f32 v44, 0x3fb8aa3b, v142
    v_mul_f32 v48, 0x3fb8aa3b, v148
    v_mul_f32 v41, 0x3e22f983, v137
    v_mul_f32 v45, 0x3e22f983, v143
    v_mul_f32 v49, 0x3e22f983, v149
    v_exp_f32 v40, v40
    v_exp_f32 v44, v44
    v_exp_f32 v48, v48
    v_fract_f32 v41, v41
    v_fract_f32 v45, v45
    v_fract_f32 v49, v49
    v_cos_f32 v162, v41
    v_cos_f32 v173, v45
    v_cos_f32 v184, v49
    v_sin_f32 v163, v41
    v_sin_f32 v174, v45
    v_sin_f32 v185, v49
    v_mul_f32 v162, v162, v40
    v_mul_f32 v173, v173, v44
    v_mul_f32 v184, v184, v48
    v_mul_f32 v163, v163, v40
    v_mul_f32 v174, v174, v44
    v_mul_f32 v185, v185, v48
    v_sub_f32 v164, 0, v163
    v_sub_f32 v175, 0, v174
    v_sub_f32 v186, 0, v185
    v_mul_f32 v40, 0x4138aa3b, v136
    v_mul_f32 v44, 0x4138aa3b, v142
    v_mul_f32 v48, 0x4138aa3b, v148
    v_mul_f32 v41, 0x3fa2f983, v137
    v_mul_f32 v45, 0x3fa2f983, v143
    v_mul_f32 v49, 0x3fa2f983, v149
    v_exp_f32 v40, v40
    v_exp_f32 v44, v44
    v_exp_f32 v48, v48
    v_fract_f32 v41, v41
    v_fract_f32 v45, v45
    v_fract_f32 v49, v49
    v_cos_f32 v165, v41
    v_cos_f32 v176, v45
    v_cos_f32 v187, v49
    v_sin_f32 v166, v41
    v_sin_f32 v177, v45
    v_sin_f32 v188, v49
    v_mul_f32 v165, v165, v40
    v_mul_f32 v176, v176, v44
    v_mul_f32 v187, v187, v48
    v_mul_f32 v166, v166, v40
    v_mul_f32 v177, v177, v44
    v_mul_f32 v188, v188, v48
    v_sub_f32 v167, 0, v166
    v_sub_f32 v178, 0, v177
    v_sub_f32 v189, 0, v188
    v_mul_f32 v40, 0x43b8aa3b, v136
    v_mul_f32 v44, 0x43b8aa3b, v142
    v_mul_f32 v48, 0x43b8aa3b, v148
    v_mul_f32 v41, 0x4222f983, v137
    v_mul_f32 v45, 0x4222f983, v143
    v_mul_f32 v49, 0x4222f983, v149
    v_exp_f32 v40, v40
    v_exp_f32 v44, v44
    v_exp_f32 v48, v48
    v_fract_f32 v41, v41
    v_fract_f32 v45, v45
    v_fract_f32 v49, v49
    v_cos_f32 v168, v41
    v_cos_f32 v179, v45
    v_cos_f32 v190, v49
    v_sin_f32 v169, v41
    v_sin_f32 v180, v45
    v_sin_f32 v191, v49
    v_mul_f32 v168, v168, v40
    v_mul_f32 v179, v179, v44
    v_mul_f32 v190, v190, v48
    v_mul_f32 v169, v169, v40
    v_mul_f32 v180, v180, v44
    v_mul_f32 v191, v191, v48
    v_sub_f32 v170, 0, v169
    v_sub_f32 v181, 0, v180
    v_sub_f32 v192, 0, v191
k_kloop:
    v_mul_f32 v118, v160, v162
    v_mul_f32 v119, v161, v162
    v_cvt_pk_bf16_f32 v126, v160, -v161
    v_fmac_f32 v118, v161, v164
    v_fmac_f32 v119, v160, v163
    ds_write_addtid_b32 v126 offset:0
    v_mul_f32 v112, v118, v162
    v_mul_f32 v113, v119, v162
    v_cvt_pk_bf16_f32 v127, v118, -v119
    v_fmac_f32 v112, v119, v164
    v_fmac_f32 v113, v118, v163
    ds_write_addtid_b32 v127 offset:272
    v_mul_f32 v118, v112, v162
    v_mul_f32 v119, v113, v162
    v_cvt_pk_bf16_f32 v126, v112, -v113
    v_fmac_f32 v118, v113, v164
    v_fmac_f32 v119, v112, v163
    ds_write_addtid_b32 v126 offset:544
    v_mul_f32 v114, v118, v162
    v_mul_f32 v115, v119, v162
    v_cvt_pk_bf16_f32 v127, v118, -v119
    v_fmac_f32 v114, v119, v164
    v_fmac_f32 v115, v118, v163
    ds_write_addtid_b32 v127 offset:816
    v_mul_f32 v118, v114, v162
    v_mul_f32 v119, v115, v162
    v_cvt_pk_bf16_f32 v126, v114, -v115
    v_fmac_f32 v118, v115, v164
    v_fmac_f32 v119, v114, v163
    ds_write_addtid_b32 v126 offset:1088
    v_mul_f32 v116, v118, v162
    v_mul_f32 v117, v119, v162
    v_cvt_pk_bf16_f32 v127, v118, -v119
    v_fmac_f32 v116, v119, v164
    v_fmac_f32 v117, v118, v163
    ds_write_addtid_b32 v127 offset:1360
    v_mul_f32 v118, v116, v162
    v_mul_f32 v119, v117, v162
    v_cvt_pk_bf16_f32 v126, v116, -v117
    v_fmac_f32 v118, v117, v164
    v_fmac_f32 v119, v116, v163
    ds_write_addtid_b32 v126 offset:1632
    v_mul_f32 v120, v112, v168
    v_mul_f32 v121, v113, v168
    v_cvt_pk_bf16_f32 v127, v118, -v119
    v_fmac_f32 v120, v113, v170
    v_fmac_f32 v121, v112, v169
    ds_write_addtid_b32 v127 offset:1904
    v_mul_f32 v118, v116, v168
    v_mul_f32 v119, v117, v168
    v_cvt_pk_bf16_f32 v126, v120, -v121
    v_fmac_f32 v118, v117, v170
    v_fmac_f32 v119, v116, v169
    ds_write_addtid_b32 v126 offset:2448
    v_mul_f32 v120, v114, v168
    v_mul_f32 v121, v115, v168
    v_cvt_pk_bf16_f32 v127, v118, -v119
    v_fmac_f32 v120, v115, v170
    v_fmac_f32 v121, v114, v169
    ds_write_addtid_b32 v127 offset:2992
    v_mul_f32 v118, v120, v168
    v_mul_f32 v119, v121, v168
    v_cvt_pk_bf16_f32 v126, v120, -v121
    v_fmac_f32 v118, v121, v170
    v_fmac_f32 v119, v120, v169
    ds_write_addtid_b32 v126 offset:2720
    v_mul_f32 v120, v118, v168
    v_mul_f32 v121, v119, v168
    v_cvt_pk_bf16_f32 v127, v118, -v119
    v_fmac_f32 v120, v119, v170
    v_fmac_f32 v121, v118, v169
    ds_write_addtid_b32 v127 offset:3536
    v_mul_f32 v118, v160, v168
    v_mul_f32 v119, v161, v168
    v_cvt_pk_bf16_f32 v126, v120, -v121
    v_fmac_f32 v118, v161, v170
    v_fmac_f32 v119, v160, v169
    ds_write_addtid_b32 v126 offset:4080
    v_mul_f32 v120, v118, v168
    v_mul_f32 v121, v119, v168
    v_cvt_pk_bf16_f32 v127, v118, -v119
    v_fmac_f32 v120, v119, v170
    v_fmac_f32 v121, v118, v169
    ds_write_addtid_b32 v127 offset:2176
    v_mul_f32 v118, v120, v168
    v_mul_f32 v119, v121, v168
    v_cvt_pk_bf16_f32 v126, v120, -v121
    v_fmac_f32 v118, v121, v170
    v_fmac_f32 v119, v120, v169
    ds_write_addtid_b32 v126 offset:3264
    v_mul_f32 v120, v118, v168
    v_mul_f32 v121, v119, v168
    v_cvt_pk_bf16_f32 v127, v118, -v119
    v_fmac_f32 v120, v119, v170
    v_fmac_f32 v121, v118, v169
    ds_write_addtid_b32 v127 offset:3808
    v_mul_f32 v118, v120, v168
    v_mul_f32 v119, v121, v168
    v_cvt_pk_bf16_f32 v126, v120, -v121
    v_fmac_f32 v118, v121, v170
    v_fmac_f32 v119, v120, v169
    ds_write_addtid_b32 v126 offset:4352
    v_mul_f32 v120, v118, v168
    v_mul_f32 v121, v119, v168
    v_cvt_pk_bf16_f32 v127, v118, -v119
    v_fmac_f32 v120, v119, v170
    v_fmac_f32 v121, v118, v169
    ds_write_addtid_b32 v127 offset:4624
    v_mul_f32 v118, v120, v168
    v_mul_f32 v119, v121, v168
    v_cvt_pk_bf16_f32 v126, v120, -v121
    v_fmac_f32 v118, v121, v170
    v_fmac_f32 v119, v120, v169
    ds_write_addtid_b32 v126 offset:4896
    v_mul_f32 v120, v118, v168
    v_mul_f32 v121, v119, v168
    v_cvt_pk_bf16_f32 v127, v118, -v119
    v_fmac_f32 v120, v119, v170
    v_fmac_f32 v121, v118, v169
    ds_write_addtid_b32 v127 offset:5168
    v_cvt_pk_bf16_f32 v126, v120, -v121
    ds_write_addtid_b32 v126 offset:5440
    ds_read_b128 v[80:83], v6 offset:0
    ds_read_b128 v[84:87], v6 offset:32
    ds_read_b128 v[88:91], v6 offset:64
    ds_read_b128 v[92:95], v6 offset:96
    ds_read_b128 v[96:99], v6 offset:128
    ds_read_b128 v[100:103], v6 offset:160
    ds_read_b128 v[104:107], v6 offset:192
    ds_read_b128 v[108:111], v6 offset:224
    ds_write_addtid_b32 v5
    v_mul_f32 v118, v165, v165
    v_mul_f32 v119, v166, v165
    v_cvt_pk_bf16_f32 v126, v165, v166
    v_fmac_f32 v118, v166, v167
    v_fmac_f32 v119, v165, v166
    ds_write_addtid_b32 v126 offset:272
    v_mul_f32 v120, v118, v165
    v_mul_f32 v121, v119, v165
    v_cvt_pk_bf16_f32 v127, v118, v119
    v_fmac_f32 v120, v119, v167
    v_fmac_f32 v121, v118, v166
    ds_write_addtid_b32 v127 offset:544
    v_mul_f32 v118, v120, v165
    v_mul_f32 v119, v121, v165
    v_cvt_pk_bf16_f32 v126, v120, v121
    v_fmac_f32 v118, v121, v167
    v_fmac_f32 v119, v120, v166
    ds_write_addtid_b32 v126 offset:816
    v_mul_f32 v120, v118, v165
    v_mul_f32 v121, v119, v165
    v_cvt_pk_bf16_f32 v127, v118, v119
    v_fmac_f32 v120, v119, v167
    v_fmac_f32 v121, v118, v166
    ds_write_addtid_b32 v127 offset:1088
    v_mul_f32 v118, v120, v165
    v_mul_f32 v119, v121, v165
    v_cvt_pk_bf16_f32 v126, v120, v121
    v_fmac_f32 v118, v121, v167
    v_fmac_f32 v119, v120, v166
    ds_write_addtid_b32 v126 offset:1360
    v_mul_f32 v120, v118, v165
    v_mul_f32 v121, v119, v165
    v_cvt_pk_bf16_f32 v127, v118, v119
    v_fmac_f32 v120, v119, v167
    v_fmac_f32 v121, v118, v166
    ds_write_addtid_b32 v127 offset:1632
    v_mul_f32 v118, v120, v165
    v_mul_f32 v119, v121, v165
    v_cvt_pk_bf16_f32 v126, v120, v121
    v_fmac_f32 v118, v121, v167
    v_fmac_f32 v119, v120, v166
    ds_write_addtid_b32 v126 offset:1904
    v_mul_f32 v120, v118, v165
    v_mul_f32 v121, v119, v165
    v_cvt_pk_bf16_f32 v127, v118, v119
    v_fmac_f32 v120, v119, v167
    v_fmac_f32 v121, v118, v166
    ds_write_addtid_b32 v127 offset:2176
    v_mul_f32 v118, v120, v165
    v_mul_f32 v119, v121, v165
    v_cvt_pk_bf16_f32 v126, v120, v121
    v_fmac_f32 v118, v121, v167
    v_fmac_f32 v119, v120, v166
    ds_write_addtid_b32 v126 offset:2448
    v_mul_f32 v120, v118, v165
    v_mul_f32 v121, v119, v165
    v_cvt_pk_bf16_f32 v127, v118, v119
    v_fmac_f32 v120, v119, v167
    v_fmac_f32 v121, v118, v166
    ds_write_addtid_b32 v127 offset:2720
    v_mul_f32 v118, v120, v165
    v_mul_f32 v119, v121, v165
    v_cvt_pk_bf16_f32 v126, v120, v121
    v_fmac_f32 v118, v121, v167
    v_fmac_f32 v119, v120, v166
    ds_write_addtid_b32 v126 offset:2992
    v_mul_f32 v120, v118, v165
    v_mul_f32 v121, v119, v165
    v_cvt_pk_bf16_f32 v127, v118, v119
    v_fmac_f32 v120, v119, v167
    v_fmac_f32 v121, v118, v166
    ds_write_addtid_b32 v127 offset:3264
    v_mul_f32 v118, v120, v165
    v_mul_f32 v119, v121, v165
    v_cvt_pk_bf16_f32 v126, v120, v121
    v_fmac_f32 v118, v121, v167
    v_fmac_f32 v119, v120, v166
    ds_write_addtid_b32 v126 offset:3536
    v_mul_f32 v120, v118, v165
    v_mul_f32 v121, v119, v165
    v_cvt_pk_bf16_f32 v127, v118, v119
    v_fmac_f32 v120, v119, v167
    v_fmac_f32 v121, v118, v166
    ds_write_addtid_b32 v127 offset:3808
    v_mul_f32 v118, v120, v165
    v_mul_f32 v119, v121, v165
    v_cvt_pk_bf16_f32 v126, v120, v121
    v_fmac_f32 v118, v121, v167
    v_fmac_f32 v119, v120, v166
    ds_write_addtid_b32 v126 offset:4080
    v_mul_f32 v120, v118, v165
    v_mul_f32 v121, v119, v165
    v_cvt_pk_bf16_f32 v127, v118, v119
    v_fmac_f32 v120, v119, v167
    v_fmac_f32 v121, v118, v166
    ds_write_addtid_b32 v127 offset:4352
    v_mul_f32 v118, v120, v165
    v_mul_f32 v119, v121, v165
    v_cvt_pk_bf16_f32 v126, v120, v121
    v_fmac_f32 v118, v121, v167
    v_fmac_f32 v119, v120, v166
    ds_write_addtid_b32 v126 offset:4624
    v_mul_f32 v120, v118, v165
    v_mul_f32 v121, v119, v165
    v_cvt_pk_bf16_f32 v127, v118, v119
    v_fmac_f32 v120, v119, v167
    v_fmac_f32 v121, v118, v166
    ds_write_addtid_b32 v127 offset:4896
    v_mul_f32 v118, v120, v165
    v_mul_f32 v119, v121, v165
    v_cvt_pk_bf16_f32 v126, v120, v121
    v_fmac_f32 v118, v121, v167
    v_fmac_f32 v119, v120, v166
    ds_write_addtid_b32 v126 offset:5168
    v_mul_f32 v120, v118, v165
    v_mul_f32 v121, v119, v165
    v_cvt_pk_bf16_f32 v127, v118, v119
    v_fmac_f32 v120, v119, v167
    v_fmac_f32 v121, v118, v166
    ds_write_addtid_b32 v127 offset:5440
    v_mul_f32 v118, v120, v165
    v_mul_f32 v119, v121, v165
    v_cvt_pk_bf16_f32 v126, v120, v121
    v_fmac_f32 v118, v121, v167
    v_fmac_f32 v119, v120, v166
    ds_write_addtid_b32 v126 offset:5712
    v_mul_f32 v120, v118, v165
    v_mul_f32 v121, v119, v165
    v_cvt_pk_bf16_f32 v127, v118, v119
    v_fmac_f32 v120, v119, v167
    v_fmac_f32 v121, v118, v166
    ds_write_addtid_b32 v127 offset:5984
    v_mul_f32 v118, v120, v165
    v_mul_f32 v119, v121, v165
    v_cvt_pk_bf16_f32 v126, v120, v121
    v_fmac_f32 v118, v121, v167
    v_fmac_f32 v119, v120, v166
    ds_write_addtid_b32 v126 offset:6256
    v_cvt_pk_bf16_f32 v127, v118, v119
    ds_write_addtid_b32 v127 offset:6528
    s_cmp_lg_u32 s46, 1
    s_cbranch_scc1 k_kskip
    buffer_load_dword v14, off, s[96:99], 0 sc1
k_kskip:
    s_cmp_lg_u32 s46, 2
    s_cbranch_scc1 k_kskip2
    s_waitcnt vmcnt(0)
L_tok_1:
    v_readfirstlane_b32 s80, v14
    s_add_u32 s41, s41, 1
    s_cmp_lg_u32 s80, 0
    s_cbranch_scc1 L_tokd_2
    s_cmp_gt_u32 s41, 50000
    s_cbranch_scc1 L_tokd_2
    s_sleep 2
    buffer_load_dword v14, off, s[96:99], 0 sc1
    s_waitcnt vmcnt(0)
    s_branch L_tok_1
L_tokd_2:
    s_mov_b32 s81, s80
    s_buffer_load_dwordx16 s[64:79], s[28:31], s52 glc
    s_buffer_load_dwordx16 s[84:99], s[28:31], s52 offset:64 glc
k_kskip2:
    v_mul_f32 v120, v118, v165
    v_mul_f32 v121, v119, v165
    v_fmac_f32 v120, v119, v167
    v_fmac_f32 v121, v118, v166
    v_mul_f32 v118, v120, v165
    v_mul_f32 v119, v121, v165
    v_cvt_pk_bf16_f32 v126, v120, v121
    v_fmac_f32 v118, v121, v167
    v_fmac_f32 v119, v120, v166
    ds_write_addtid_b32 v126 offset:6800
    v_mul_f32 v120, v118, v165
    v_mul_f32 v121, v119, v165
    v_cvt_pk_bf16_f32 v127, v118, v119
    v_fmac_f32 v120, v119, v167
    v_fmac_f32 v121, v118, v166
    ds_write_addtid_b32 v127 offset:7072
    v_mul_f32 v118, v120, v165
    v_mul_f32 v119, v121, v165
    v_cvt_pk_bf16_f32 v126, v120, v121
    v_fmac_f32 v118, v121, v167
    v_fmac_f32 v119, v120, v166
    ds_write_addtid_b32 v126 offset:7344
    v_mul_f32 v120, v118, v165
    v_mul_f32 v121, v119, v165
    v_cvt_pk_bf16_f32 v127, v118, v119
    v_fmac_f32 v120, v119, v167
    v_fmac_f32 v121, v118, v166
    ds_write_addtid_b32 v127 offset:7616
    v_mul_f32 v118, v120, v165
    v_mul_f32 v119, v121, v165
    v_cvt_pk_bf16_f32 v126, v120, v121
    v_fmac_f32 v118, v121, v167
    v_fmac_f32 v119, v120, v166
    ds_write_addtid_b32 v126 offset:7888
    v_mul_f32 v120, v118, v165
    v_mul_f32 v121, v119, v165
    v_cvt_pk_bf16_f32 v127, v118, v119
    v_fmac_f32 v120, v119, v167
    v_fmac_f32 v121, v118, v166
    ds_write_addtid_b32 v127 offset:8160
    v_cvt_pk_bf16_f32 v126, v120, v121
    ds_write_addtid_b32 v126 offset:8432
    s_add_u32 s46, s46, 1
    ds_read_b128 v[200:203], v6 offset:0
    ds_read_b128 v[204:207], v6 offset:32
    ds_read_b128 v[208:211], v6 offset:64
    ds_read_b128 v[212:215], v6 offset:96
    ds_read_b128 v[216:219], v6 offset:128
    ds_read_b128 v[220:223], v6 offset:160
    ds_read_b128 v[224:227], v6 offset:192
    ds_read_b128 v[228:231], v6 offset:224
    v_mov_b32 v160, v171
    v_mov_b32 v161, v172
    v_mov_b32 v162, v173
    v_mov_b32 v163, v174
    v_mov_b32 v164, v175
    v_mov_b32 v165, v176
    v_mov_b32 v166, v177
    v_mov_b32 v167, v178
    v_mov_b32 v168, v179
    v_mov_b32 v169, v180
    v_mov_b32 v170, v181
    v_mov_b32 v171, v182
    v_mov_b32 v172, v183
    v_mov_b32 v173, v184
    v_mov_b32 v174, v185
    v_mov_b32 v175, v186
    v_mov_b32 v176, v187
    v_mov_b32 v177, v188
    v_mov_b32 v178, v189
    v_mov_b32 v179, v190
    v_mov_b32 v180, v191
    v_mov_b32 v181, v192
    s_waitcnt lgkmcnt(0)
    s_setprio 3
    v_mfma_f32_32x32x16_bf16 v[64:79], v[80:83], v[200:203], v[64:79]
    v_mfma_f32_32x32x16_bf16 v[64:79], v[84:87], v[204:207], v[64:79]
    v_mfma_f32_32x32x16_bf16 v[64:79], v[88:91], v[208:211], v[64:79]
    v_mfma_f32_32x32x16_bf16 v[64:79], v[92:95], v[212:215], v[64:79]
    v_mfma_f32_32x32x16_bf16 v[64:79], v[96:99], v[216:219], v[64:79]
    v_mfma_f32_32x32x16_bf16 v[64:79], v[100:103], v[220:223], v[64:79]
    v_mfma_f32_32x32x16_bf16 v[64:79], v[104:107], v[224:227], v[64:79]
    v_mfma_f32_32x32x16_bf16 v[64:79], v[108:111], v[228:231], v[64:79]
    s_setprio 1
    s_cmp_lt_u32 s46, 3
    s_cbranch_scc1 k_kloop
    s_branch k_s2
k_g2:
    s_setprio 2
    s_mov_b32 s12, s84
    s_mov_b32 s13, s85
    s_mov_b32 s14, 0x1e0000
    s_mov_b32 s15, 0x20000
    s_lshr_b32 s35, s39, 1
    s_lshl_b32 s37, s34, 1
    s_add_u32 s37, s37, s35
    s_mul_i32 s37, s37, 192
    s_and_b32 s35, s39, 1
    s_lshl_b32 s36, s35, 6
    s_lshl_b32 s35, s35, 5
    s_add_u32 s35, s35, 64
    v_add_u32 v160, 0, v1
    v_add_u32 v166, 64, v1
    v_add_u32 v172, 128, v1
    v_mul_u32_u24 v161, 171, v160
    v_mul_u32_u24 v167, 171, v166
    v_mul_u32_u24 v173, 171, v172
    v_lshrrev_b32 v161, 10, v161
    v_lshrrev_b32 v167, 10, v167
    v_lshrrev_b32 v173, 10, v173
    v_mul_u32_u24 v162, 6, v161
    v_mul_u32_u24 v168, 6, v167
    v_mul_u32_u24 v174, 6, v173
    v_sub_u32 v162, v160, v162
    v_sub_u32 v168, v166, v168
    v_sub_u32 v174, v172, v174
    v_bfe_u32 v163, v161, 2, 2
    v_bfe_u32 v169, v167, 2, 2
    v_bfe_u32 v175, v173, 2, 2
    v_lshrrev_b32 v164, 4, v161
    v_lshrrev_b32 v170, 4, v167
    v_lshrrev_b32 v176, 4, v173
    v_and_b32 v165, 3, v161
    v_and_b32 v171, 3, v167
    v_and_b32 v177, 3, v173
    v_lshl_add_u32 v165, v163, 3, v165
    v_lshl_add_u32 v171, v169, 3, v171
    v_lshl_add_u32 v177, v175, 3, v177
    v_lshl_add_u32 v165, v164, 2, v165
    v_lshl_add_u32 v171, v170, 2, v171
    v_lshl_add_u32 v177, v176, 2, v177
    v_mul_u32_u24 v165, 3072, v165
    v_mul_u32_u24 v171, 3072, v171
    v_mul_u32_u24 v177, 3072, v177
    v_mov_b32 v163, s36
    v_mov_b32 v169, s36
    v_mov_b32 v175, s36
    v_mov_b32 v164, s35
    v_mov_b32 v170, s35
    v_mov_b32 v176, s35
    v_cmp_gt_u32 s[56:57], 4, v162
    v_cmp_gt_u32 s[58:59], 4, v168
    v_cmp_gt_u32 s[60:61], 4, v174
    v_lshl_add_u32 v165, v162, 4, v165
    v_lshl_add_u32 v171, v168, 4, v171
    v_lshl_add_u32 v177, v174, 4, v177
    v_cndmask_b32 v163, v164, v163, s[56:57]
    v_cndmask_b32 v169, v170, v169, s[58:59]
    v_cndmask_b32 v175, v176, v175, s[60:61]
    v_add_u32 v165, v165, v163
    v_add_u32 v171, v171, v169
    v_add_u32 v177, v177, v175
    v_subrev_u32 v5, 0, v165
    v_subrev_u32 v6, 1024, v171
    v_subrev_u32 v7, 2048, v177
    s_add_u32 s48, s36, s37
    s_add_u32 s49, s35, s37
    s_mul_i32 s38, s39, 12288
    s_add_u32 s38, s38, 32768
    s_mul_i32 s46, s45, 196608
    s_add_u32 s46, s46, s37
    s_add_u32 s47, s37, 1966080
    s_add_u32 m0, s43, 12288
    s_nop 0
    buffer_load_dwordx4 v13, s[8:11], s72 offen lds
    s_add_u32 m0, s43, 14336
    s_nop 0
    buffer_load_dwordx4 v13, s[8:11], s73 offen lds
    s_add_u32 m0, s43, 16384
    s_nop 0
    buffer_load_dwordx4 v13, s[8:11], s74 offen lds
    s_add_u32 m0, s43, 18432
    s_nop 0
    buffer_load_dwordx4 v13, s[8:11], s75 offen lds
    s_add_u32 m0, s76, 0
    s_nop 0
    s_waitcnt vmcnt(9)
    buffer_load_dwordx4 v14, s[8:11], s66 offen lds
    s_add_u32 m0, s76, 2048
    s_nop 0
    s_waitcnt vmcnt(9)
    buffer_load_dwordx4 v14, s[8:11], s67 offen lds
    v_and_b32 v2, 15, v1
    v_lshrrev_b32 v3, 1, v2
    v_xor_b32 v3, v3, v12
    v_lshlrev_b32 v3, 4, v3
    v_lshl_add_u32 v3, v2, 7, v3
    v_add_u32 v178, 81920, v3
    v_add_u32 v179, 122880, v3
    v_xor_b32 v180, 64, v178
    v_xor_b32 v181, 64, v179
    s_mul_i32 s35, s39, 20480
    v_add_u32 v8, s35, v178
    v_add_u32 v9, s35, v180
    v_lshlrev_b32 v10, 1, v2
    v_lshlrev_b32 v182, 4, v2
    v_add_u32 v182, 31296, v182
    s_lshl_b32 s35, s39, 8
    v_add_u32 v183, s35, v182
    v_lshrrev_b32 v2, 2, v1
    v_and_b32 v3, 3, v1
    v_mul_u32_u24 v11, 96, v2
    v_lshl_add_u32 v11, v3, 3, v11
    v_add_u32 v11, s38, v11
    v_mov_b32 v244, 0x3f803f80
    v_mov_b32 v245, 0x3f803f80
    v_mov_b32 v246, 0x3f803f80
    v_mov_b32 v247, 0x3f803f80
    v_mov_b32 v42, 0
    v_mov_b32 v43, 0
    v_mov_b32 v46, 0
    v_mov_b32 v47, 0
    v_mov_b32 v50, 0
    v_mov_b32 v51, 0
    s_add_u32 s28, s6, 0xf00000
    s_addc_u32 s29, s7, 0
    s_mov_b32 s30, 0x40000
    s_mov_b32 s31, 0x20000
    s_mov_b32 s96, s94
    s_mov_b32 s97, s95
    s_mov_b32 s98, 0x100
    s_mov_b32 s99, 0x20000
    s_mov_b32 s16, s86
    s_mov_b32 s17, s87
    s_mov_b32 s18, 0xc00
    s_mov_b32 s19, 0x20000
    s_mov_b32 s20, s6
    s_mov_b32 s21, s7
    s_mov_b32 s22, 0x600000
    s_mov_b32 s23, 0x20000
    s_add_u32 s24, s6, 0xd00000
    s_addc_u32 s25, s7, 0
    s_mov_b32 s26, 0x1e0000
    s_mov_b32 s27, 0x20000
    s_mov_b32 s50, 0xaaaaaaaa
    s_mov_b32 s51, 0xaaaaaaaa
    s_mov_b32 s52, 0xcccccccc
    s_mov_b32 s53, 0xcccccccc
    s_lshl_b32 s62, s33, 3
    s_add_u32 s62, s62, s34
    s_lshl_b32 s62, s62, 2
    s_add_u32 s62, s62, s39
    s_lshl_b32 s62, s62, 7
    v_mov_b32 v177, 1
    s_add_u32 m0, s76, 4096
    s_nop 0
    s_waitcnt vmcnt(9)
    buffer_load_dwordx4 v14, s[8:11], s68 offen lds
    s_add_u32 m0, s76, 6144
    s_nop 0
    s_waitcnt vmcnt(9)
    buffer_load_dwordx4 v14, s[8:11], s69 offen lds
    s_add_u32 m0, s76, 8192
    s_nop 0
    s_waitcnt vmcnt(9)
    buffer_load_dwordx4 v14, s[8:11], s70 offen lds
    s_add_u32 m0, s76, 10240
    s_nop 0
    s_waitcnt vmcnt(9)
    buffer_load_dwordx4 v14, s[8:11], s71 offen lds
    s_add_u32 m0, s76, 12288
    s_nop 0
    s_waitcnt vmcnt(9)
    buffer_load_dwordx4 v14, s[8:11], s72 offen lds
    s_add_u32 m0, s76, 14336
    s_nop 0
    s_waitcnt vmcnt(9)
    buffer_load_dwordx4 v14, s[8:11], s73 offen lds
    s_add_u32 m0, s76, 16384
    s_nop 0
    s_waitcnt vmcnt(9)
    buffer_load_dwordx4 v14, s[8:11], s74 offen lds
    s_add_u32 m0, s76, 18432
    s_nop 0
    s_waitcnt vmcnt(9)
    buffer_load_dwordx4 v14, s[8:11], s75 offen lds
    s_add_u32 m0, s38, 0
    s_nop 0
    s_waitcnt vmcnt(9)
    buffer_load_dwordx4 v5, s[12:15], s46 offen offset:0 lds
    s_waitcnt vmcnt(9)
    buffer_load_dwordx4 v6, s[12:15], s46 offen offset:1024 lds
    s_waitcnt vmcnt(9)
    buffer_load_dwordx4 v7, s[12:15], s46 offen offset:2048 lds
    s_add_u32 s46, s46, 98304
    s_cmp_eq_u32 s46, s47
    s_cselect_b32 s46, s37, s46
    s_add_u32 m0, s38, 3072
    s_nop 0
    s_waitcnt vmcnt(9)
    buffer_load_dwordx4 v5, s[12:15], s46 offen offset:0 lds
    s_waitcnt vmcnt(9)
    buffer_load_dwordx4 v6, s[12:15], s46 offen offset:1024 lds
    s_waitcnt vmcnt(9)
    buffer_load_dwordx4 v7, s[12:15], s46 offen offset:2048 lds
    s_add_u32 s46, s46, 98304
    s_cmp_eq_u32 s46, s47
    s_cselect_b32 s46, s37, s46
    ds_read_b128 v[56:59], v8 offset:0
    ds_read_b128 v[60:63], v9 offset:0
    ds_read_b128 v[64:67], v8 offset:2048
    ds_read_b128 v[68:71], v9 offset:2048
    ds_read_b128 v[72:75], v8 offset:4096
    ds_read_b128 v[76:79], v9 offset:4096
    s_waitcnt lgkmcnt(4)
    v_mfma_f32_16x16x32_bf16 v[152:155], v[56:59], v[56:59], 0
    v_mfma_f32_16x16x32_bf16 v[156:159], v[244:247], v[56:59], 0
    v_mfma_f32_16x16x32_bf16 v[152:155], v[60:63], v[60:63], v[152:155]
    v_mfma_f32_16x16x32_bf16 v[156:159], v[244:247], v[60:63], v[156:159]
    ds_read_b128 v[80:83], v8 offset:6144
    ds_read_b128 v[84:87], v9 offset:6144
    s_waitcnt lgkmcnt(4)
    v_mfma_f32_16x16x32_bf16 v[152:155], v[64:67], v[64:67], v[152:155]
    v_mfma_f32_16x16x32_bf16 v[156:159], v[244:247], v[64:67], v[156:159]
    v_mfma_f32_16x16x32_bf16 v[152:155], v[68:71], v[68:71], v[152:155]
    v_mfma_f32_16x16x32_bf16 v[156:159], v[244:247], v[68:71], v[156:159]
    ds_read_b128 v[56:59], v8 offset:8192
    ds_read_b128 v[60:63], v9 offset:8192
    s_waitcnt lgkmcnt(4)
    v_mfma_f32_16x16x32_bf16 v[152:155], v[72:75], v[72:75], v[152:155]
    v_mfma_f32_16x16x32_bf16 v[156:159], v[244:247], v[72:75], v[156:159]
    v_mfma_f32_16x16x32_bf16 v[152:155], v[76:79], v[76:79], v[152:155]
    v_mfma_f32_16x16x32_bf16 v[156:159], v[244:247], v[76:79], v[156:159]
    ds_read_b128 v[64:67], v8 offset:10240
    ds_read_b128 v[68:71], v9 offset:10240
    s_waitcnt lgkmcnt(4)
    v_mfma_f32_16x16x32_bf16 v[152:155], v[80:83], v[80:83], v[152:155]
    v_mfma_f32_16x16x32_bf16 v[156:159], v[244:247], v[80:83], v[156:159]
    v_mfma_f32_16x16x32_bf16 v[152:155], v[84:87], v[84:87], v[152:155]
    v_mfma_f32_16x16x32_bf16 v[156:159], v[244:247], v[84:87], v[156:159]
    s_waitcnt vmcnt(9)
    ds_read_b128 v[72:75], v8 offset:12288
    ds_read_b128 v[76:79], v9 offset:12288
    s_waitcnt lgkmcnt(4)
    v_mfma_f32_16x16x32_bf16 v[152:155], v[56:59], v[56:59], v[152:155]
    v_mfma_f32_16x16x32_bf16 v[156:159], v[244:247], v[56:59], v[156:159]
    v_mfma_f32_16x16x32_bf16 v[152:155], v[60:63], v[60:63], v[152:155]
    v_mfma_f32_16x16x32_bf16 v[156:159], v[244:247], v[60:63], v[156:159]
    s_waitcnt vmcnt(8)
    ds_read_b128 v[80:83], v8 offset:14336
    ds_read_b128 v[84:87], v9 offset:14336
    s_waitcnt lgkmcnt(4)
    v_mfma_f32_16x16x32_bf16 v[152:155], v[64:67], v[64:67], v[152:155]
    v_mfma_f32_16x16x32_bf16 v[156:159], v[244:247], v[64:67], v[156:159]
    v_mfma_f32_16x16x32_bf16 v[152:155], v[68:71], v[68:71], v[152:155]
    v_mfma_f32_16x16x32_bf16 v[156:159], v[244:247], v[68:71], v[156:159]
    s_waitcnt vmcnt(7)
    ds_read_b128 v[56:59], v8 offset:16384
    ds_read_b128 v[60:63], v9 offset:16384
    s_waitcnt lgkmcnt(4)
    v_mfma_f32_16x16x32_bf16 v[152:155], v[72:75], v[72:75], v[152:155]
    v_mfma_f32_16x16x32_bf16 v[156:159], v[244:247], v[72:75], v[156:159]
    v_mfma_f32_16x16x32_bf16 v[152:155], v[76:79], v[76:79], v[152:155]
    v_mfma_f32_16x16x32_bf16 v[156:159], v[244:247], v[76:79], v[156:159]
    s_waitcnt vmcnt(6)
    ds_read_b128 v[64:67], v8 offset:18432
    ds_read_b128 v[68:71], v9 offset:18432
    s_mov_b64 exec, 1
    ds_add_u32 v15, v177 offset:0
    s_mov_b64 exec, -1
    s_waitcnt lgkmcnt(5)
    v_mfma_f32_16x16x32_bf16 v[152:155], v[80:83], v[80:83], v[152:155]
    v_mfma_f32_16x16x32_bf16 v[156:159], v[244:247], v[80:83], v[156:159]
    v_mfma_f32_16x16x32_bf16 v[152:155], v[84:87], v[84:87], v[152:155]
    v_mfma_f32_16x16x32_bf16 v[156:159], v[244:247], v[84:87], v[156:159]
    s_waitcnt lgkmcnt(3)
    v_mfma_f32_16x16x32_bf16 v[152:155], v[56:59], v[56:59], v[152:155]
    v_mfma_f32_16x16x32_bf16 v[156:159], v[244:247], v[56:59], v[156:159]
    v_mfma_f32_16x16x32_bf16 v[152:155], v[60:63], v[60:63], v[152:155]
    v_mfma_f32_16x16x32_bf16 v[156:159], v[244:247], v[60:63], v[156:159]
    s_waitcnt lgkmcnt(1)
    v_mfma_f32_16x16x32_bf16 v[152:155], v[64:67], v[64:67], v[152:155]
    v_mfma_f32_16x16x32_bf16 v[156:159], v[244:247], v[64:67], v[156:159]
    v_mfma_f32_16x16x32_bf16 v[152:155], v[68:71], v[68:71], v[152:155]
    v_mfma_f32_16x16x32_bf16 v[156:159], v[244:247], v[68:71], v[156:159]
    s_nop 7
    v_cndmask_b32 v152, v152, v153, s[50:51]
    v_cndmask_b32 v154, v154, v155, s[50:51]
    v_mul_f32 v156, 0x3acccccd, v156
    v_cndmask_b32 v152, v152, v154, s[52:53]
    v_cvt_pk_bf16_f32 v160, -v156, -v156
    v_mul_f32 v152, 0x3acccccd, v152
    v_and_b32 v163, s44, v160
    v_fma_f32 v152, -v156, v156, v152
    v_max_f32 v152, 0, v152
    v_cvt_pk_bf16_f32 v152, v152, v152
    v_lshlrev_b32 v152, 16, v152
    v_add_f32 v152, 0x3727c5ac, v152
    v_cvt_pk_bf16_f32 v152, v152, v152
    v_lshlrev_b32 v152, 16, v152
    v_sqrt_f32 v152, v152
    s_nop 0
    v_cvt_pk_bf16_f32 v161, -v156, v152
    v_and_b32 v152, s44, v161
    v_rcp_f32 v162, v152
    s_nop 0
    v_mul_f32 v163, v163, v162
    s_mov_b32 exec_lo, 0x00f0000f
    s_mov_b32 exec_hi, 0xf0000f00
    ds_write_b128 v183, v[160:163]
    s_mov_b64 exec, 1
    ds_add_u32 v15, v177 offset:20
    s_mov_b64 exec, -1
    s_mov_b64 s[50:51], 0xffff
    s_add_u32 m0, s38, 6144
    s_nop 0
    buffer_load_dwordx4 v5, s[12:15], s46 offen offset:0 lds
    buffer_load_dwordx4 v6, s[12:15], s46 offen offset:1024 lds
    buffer_load_dwordx4 v7, s[12:15], s46 offen offset:2048 lds
    s_add_u32 s46, s46, 98304
    s_cmp_eq_u32 s46, s47
    s_cselect_b32 s46, s37, s46
    s_add_u32 m0, s38, 9216
    s_nop 0
    buffer_load_dwordx4 v5, s[12:15], s46 offen offset:0 lds
    s_waitcnt vmcnt(9)
    buffer_load_dwordx4 v6, s[12:15], s46 offen offset:1024 lds
    s_waitcnt vmcnt(9)
    buffer_load_dwordx4 v7, s[12:15], s46 offen offset:2048 lds
    s_add_u32 s46, s46, 98304
    s_cmp_eq_u32 s46, s47
    s_cselect_b32 s46, s37, s46
L_cw_3:
    ds_read_b32 v2, v15 offset:0
    s_add_u32 s41, s41, 1
    s_cmp_gt_u32 s41, 400000
    s_waitcnt lgkmcnt(0)
    s_cbranch_scc1 L_cwd_4
    v_readfirstlane_b32 s64, v2
    s_cmp_ge_u32 s64, 4
    s_cbranch_scc1 L_cwd_4
    s_branch L_cw_3
L_cwd_4:
    s_mov_b32 s41, 0
    ds_read_b128 v[108:111], v178 offset:0
    ds_read_b128 v[112:115], v178 offset:20480
    ds_read_b128 v[116:119], v179 offset:0
    ds_read_b128 v[120:123], v179 offset:20480
    s_waitcnt vmcnt(9)
    ds_read_b64_tr_b16 v[96:97], v11 offset:0
    ds_read_b64_tr_b16 v[98:99], v11 offset:1536
    ds_read_b64_tr_b16 v[100:101], v11 offset:32
    ds_read_b64_tr_b16 v[102:103], v11 offset:1568
    ds_read_b64_tr_b16 v[104:105], v11 offset:64
    ds_read_b64_tr_b16 v[106:107], v11 offset:1600
    s_waitcnt lgkmcnt(0)
    v_mfma_f32_16x16x32_bf16 v[232:235], v[244:247], v[96:99], 0
    s_add_u32 m0, s38, 0
    s_nop 0
    buffer_load_dwordx4 v5, s[12:15], s46 offen offset:0 lds
    v_mfma_f32_16x16x32_bf16 v[236:239], v[244:247], v[100:103], 0
    buffer_load_dwordx4 v6, s[12:15], s46 offen offset:1024 lds
    v_mfma_f32_16x16x32_bf16 v[240:243], v[244:247], v[104:107], 0
    buffer_load_dwordx4 v7, s[12:15], s46 offen offset:2048 lds
    s_add_u32 s46, s46, 98304
    s_cmp_eq_u32 s46, s47
    s_cselect_b32 s46, s37, s46
    v_mfma_f32_16x16x32_bf16 v[184:187], v[96:99], v[108:111], 0
    v_mfma_f32_16x16x32_bf16 v[200:203], v[100:103], v[108:111], 0
    ds_read_b128 v[136:139], v180 offset:0
    v_mfma_f32_16x16x32_bf16 v[216:219], v[104:107], v[108:111], 0
    s_waitcnt vmcnt(9)
    ds_read_b64_tr_b16 v[124:125], v11 offset:3072
    ds_read_b64_tr_b16 v[126:127], v11 offset:4608
    v_mfma_f32_16x16x32_bf16 v[188:191], v[96:99], v[112:115], 0
    ds_read_b64_tr_b16 v[128:129], v11 offset:3104
    ds_read_b64_tr_b16 v[130:131], v11 offset:4640
    v_mfma_f32_16x16x32_bf16 v[204:207], v[100:103], v[112:115], 0
    ds_read_b64_tr_b16 v[132:133], v11 offset:3136
    ds_read_b64_tr_b16 v[134:135], v11 offset:4672
    v_mfma_f32_16x16x32_bf16 v[220:223], v[104:107], v[112:115], 0
    ds_read_b128 v[140:143], v180 offset:20480
    v_mfma_f32_16x16x32_bf16 v[192:195], v[96:99], v[116:119], 0
    ds_read_b128 v[144:147], v181 offset:0
    v_mfma_f32_16x16x32_bf16 v[208:211], v[100:103], v[116:119], 0
    ds_read_b128 v[148:151], v181 offset:20480
    v_mfma_f32_16x16x32_bf16 v[224:227], v[104:107], v[116:119], 0
    v_mfma_f32_16x16x32_bf16 v[196:199], v[96:99], v[120:123], 0
    v_mfma_f32_16x16x32_bf16 v[212:215], v[100:103], v[120:123], 0
    v_mfma_f32_16x16x32_bf16 v[228:231], v[104:107], v[120:123], 0
    s_waitcnt lgkmcnt(3)
    v_mfma_f32_16x16x32_bf16 v[232:235], v[244:247], v[124:127], v[232:235]
    s_add_u32 m0, s38, 3072
    s_nop 0
    buffer_load_dwordx4 v5, s[12:15], s46 offen offset:0 lds
    v_mfma_f32_16x16x32_bf16 v[236:239], v[244:247], v[128:131], v[236:239]
    buffer_load_dwordx4 v6, s[12:15], s46 offen offset:1024 lds
    v_mfma_f32_16x16x32_bf16 v[240:243], v[244:247], v[132:135], v[240:243]
    buffer_load_dwordx4 v7, s[12:15], s46 offen offset:2048 lds
    s_add_u32 s46, s46, 98304
    s_cmp_eq_u32 s46, s47
    s_cselect_b32 s46, s37, s46
    v_mfma_f32_16x16x32_bf16 v[184:187], v[124:127], v[136:139], v[184:187]
    v_mfma_f32_16x16x32_bf16 v[200:203], v[128:131], v[136:139], v[200:203]
    ds_read_b128 v[108:111], v178 offset:2048
    v_mfma_f32_16x16x32_bf16 v[216:219], v[132:135], v[136:139], v[216:219]
    s_waitcnt vmcnt(9)
    ds_read_b64_tr_b16 v[96:97], v11 offset:6144
    ds_read_b64_tr_b16 v[98:99], v11 offset:7680
    s_waitcnt lgkmcnt(5)
    v_mfma_f32_16x16x32_bf16 v[188:191], v[124:127], v[140:143], v[188:191]
    ds_read_b64_tr_b16 v[100:101], v11 offset:6176
    ds_read_b64_tr_b16 v[102:103], v11 offset:7712
    v_mfma_f32_16x16x32_bf16 v[204:207], v[128:131], v[140:143], v[204:207]
    ds_read_b64_tr_b16 v[104:105], v11 offset:6208
    ds_read_b64_tr_b16 v[106:107], v11 offset:7744
    v_mfma_f32_16x16x32_bf16 v[220:223], v[132:135], v[140:143], v[220:223]
    ds_read_b128 v[112:115], v178 offset:22528
    s_waitcnt lgkmcnt(9)
    v_mfma_f32_16x16x32_bf16 v[192:195], v[124:127], v[144:147], v[192:195]
    ds_read_b128 v[116:119], v179 offset:2048
    v_mfma_f32_16x16x32_bf16 v[208:211], v[128:131], v[144:147], v[208:211]
    ds_read_b128 v[120:123], v179 offset:22528
    v_mfma_f32_16x16x32_bf16 v[224:227], v[132:135], v[144:147], v[224:227]
    s_waitcnt lgkmcnt(10)
    v_mfma_f32_16x16x32_bf16 v[196:199], v[124:127], v[148:151], v[196:199]
    v_mfma_f32_16x16x32_bf16 v[212:215], v[128:131], v[148:151], v[212:215]
    v_mfma_f32_16x16x32_bf16 v[228:231], v[132:135], v[148:151], v[228:231]
    s_waitcnt lgkmcnt(3)
    v_mfma_f32_16x16x32_bf16 v[232:235], v[244:247], v[96:99], v[232:235]
    s_add_u32 m0, s38, 6144
    s_nop 0
    buffer_load_dwordx4 v5, s[12:15], s46 offen offset:0 lds
    v_mfma_f32_16x16x32_bf16 v[236:239], v[244:247], v[100:103], v[236:239]
    buffer_load_dwordx4 v6, s[12:15], s46 offen offset:1024 lds
    v_mfma_f32_16x16x32_bf16 v[240:243], v[244:247], v[104:107], v[240:243]
    buffer_load_dwordx4 v7, s[12:15], s46 offen offset:2048 lds
    s_add_u32 s46, s46, 98304
    s_cmp_eq_u32 s46, s47
    s_cselect_b32 s46, s37, s46
    v_mfma_f32_16x16x32_bf16 v[184:187], v[96:99], v[108:111], v[184:187]
    v_mfma_f32_16x16x32_bf16 v[200:203], v[100:103], v[108:111], v[200:203]
    ds_read_b128 v[136:139], v180 offset:2048
    v_mfma_f32_16x16x32_bf16 v[216:219], v[104:107], v[108:111], v[216:219]
    s_waitcnt vmcnt(9)
    ds_read_b64_tr_b16 v[124:125], v11 offset:9216
    ds_read_b64_tr_b16 v[126:127], v11 offset:10752
    s_waitcnt lgkmcnt(5)
    v_mfma_f32_16x16x32_bf16 v[188:191], v[96:99], v[112:115], v[188:191]
    ds_read_b64_tr_b16 v[128:129], v11 offset:9248
    ds_read_b64_tr_b16 v[130:131], v11 offset:10784
    v_mfma_f32_16x16x32_bf16 v[204:207], v[100:103], v[112:115], v[204:207]
    ds_read_b64_tr_b16 v[132:133], v11 offset:9280
    ds_read_b64_tr_b16 v[134:135], v11 offset:10816
    v_mfma_f32_16x16x32_bf16 v[220:223], v[104:107], v[112:115], v[220:223]
    ds_read_b128 v[140:143], v180 offset:22528
    s_waitcnt lgkmcnt(9)
    v_mfma_f32_16x16x32_bf16 v[192:195], v[96:99], v[116:119], v[192:195]
    ds_read_b128 v[144:147], v181 offset:2048
    v_mfma_f32_16x16x32_bf16 v[208:211], v[100:103], v[116:119], v[208:211]
    ds_read_b128 v[148:151], v181 offset:22528
    v_mfma_f32_16x16x32_bf16 v[224:227], v[104:107], v[116:119], v[224:227]
    s_waitcnt lgkmcnt(10)
    v_mfma_f32_16x16x32_bf16 v[196:199], v[96:99], v[120:123], v[196:199]
    v_mfma_f32_16x16x32_bf16 v[212:215], v[100:103], v[120:123], v[212:215]
    v_mfma_f32_16x16x32_bf16 v[228:231], v[104:107], v[120:123], v[228:231]
    s_waitcnt lgkmcnt(3)
    v_mfma_f32_16x16x32_bf16 v[232:235], v[244:247], v[124:127], v[232:235]
    s_add_u32 m0, s38, 9216
    s_nop 0
    buffer_load_dwordx4 v5, s[12:15], s46 offen offset:0 lds
    v_mfma_f32_16x16x32_bf16 v[236:239], v[244:247], v[128:131], v[236:239]
    buffer_load_dwordx4 v6, s[12:15], s46 offen offset:1024 lds
    v_mfma_f32_16x16x32_bf16 v[240:243], v[244:247], v[132:135], v[240:243]
    buffer_load_dwordx4 v7, s[12:15], s46 offen offset:2048 lds
    s_add_u32 s46, s46, 98304
    s_cmp_eq_u32 s46, s47
    s_cselect_b32 s46, s37, s46
    v_mfma_f32_16x16x32_bf16 v[184:187], v[124:127], v[136:139], v[184:187]
    v_mfma_f32_16x16x32_bf16 v[200:203], v[128:131], v[136:139], v[200:203]
    ds_read_b128 v[108:111], v178 offset:4096
    v_mfma_f32_16x16x32_bf16 v[216:219], v[132:135], v[136:139], v[216:219]
    s_waitcnt vmcnt(9)
    ds_read_b64_tr_b16 v[96:97], v11 offset:0
    ds_read_b64_tr_b16 v[98:99], v11 offset:1536
    s_waitcnt lgkmcnt(5)
    v_mfma_f32_16x16x32_bf16 v[188:191], v[124:127], v[140:143], v[188:191]
    ds_read_b64_tr_b16 v[100:101], v11 offset:32
    ds_read_b64_tr_b16 v[102:103], v11 offset:1568
    v_mfma_f32_16x16x32_bf16 v[204:207], v[128:131], v[140:143], v[204:207]
    ds_read_b64_tr_b16 v[104:105], v11 offset:64
    ds_read_b64_tr_b16 v[106:107], v11 offset:1600
    v_mfma_f32_16x16x32_bf16 v[220:223], v[132:135], v[140:143], v[220:223]
    ds_read_b128 v[112:115], v178 offset:24576
    s_waitcnt lgkmcnt(9)
    v_mfma_f32_16x16x32_bf16 v[192:195], v[124:127], v[144:147], v[192:195]
    ds_read_b128 v[116:119], v179 offset:4096
    v_mfma_f32_16x16x32_bf16 v[208:211], v[128:131], v[144:147], v[208:211]
    ds_read_b128 v[120:123], v179 offset:24576
    v_mfma_f32_16x16x32_bf16 v[224:227], v[132:135], v[144:147], v[224:227]
    s_waitcnt lgkmcnt(10)
    v_mfma_f32_16x16x32_bf16 v[196:199], v[124:127], v[148:151], v[196:199]
    v_mfma_f32_16x16x32_bf16 v[212:215], v[128:131], v[148:151], v[212:215]
    v_mfma_f32_16x16x32_bf16 v[228:231], v[132:135], v[148:151], v[228:231]
    s_waitcnt lgkmcnt(3)
    v_mfma_f32_16x16x32_bf16 v[232:235], v[244:247], v[96:99], v[232:235]
    s_add_u32 m0, s38, 0
    s_nop 0
    buffer_load_dwordx4 v5, s[12:15], s46 offen offset:0 lds
    v_mfma_f32_16x16x32_bf16 v[236:239], v[244:247], v[100:103], v[236:239]
    buffer_load_dwordx4 v6, s[12:15], s46 offen offset:1024 lds
    v_mfma_f32_16x16x32_bf16 v[240:243], v[244:247], v[104:107], v[240:243]
    buffer_load_dwordx4 v7, s[12:15], s46 offen offset:2048 lds
    s_add_u32 s46, s46, 98304
    s_cmp_eq_u32 s46, s47
    s_cselect_b32 s46, s37, s46
    v_mfma_f32_16x16x32_bf16 v[184:187], v[96:99], v[108:111], v[184:187]
    ds_read_b32 v176, v15 offset:20
    v_mfma_f32_16x16x32_bf16 v[200:203], v[100:103], v[108:111], v[200:203]
    ds_read_b128 v[136:139], v180 offset:4096
    v_mfma_f32_16x16x32_bf16 v[216:219], v[104:107], v[108:111], v[216:219]
    s_waitcnt vmcnt(9)
    ds_read_b64_tr_b16 v[124:125], v11 offset:3072
    ds_read_b64_tr_b16 v[126:127], v11 offset:4608
    s_waitcnt lgkmcnt(6)
    v_mfma_f32_16x16x32_bf16 v[188:191], v[96:99], v[112:115], v[188:191]
    ds_read_b64_tr_b16 v[128:129], v11 offset:3104
    ds_read_b64_tr_b16 v[130:131], v11 offset:4640
    v_mfma_f32_16x16x32_bf16 v[204:207], v[100:103], v[112:115], v[204:207]
    ds_read_b64_tr_b16 v[132:133], v11 offset:3136
    ds_read_b64_tr_b16 v[134:135], v11 offset:4672
    v_mfma_f32_16x16x32_bf16 v[220:223], v[104:107], v[112:115], v[220:223]
    ds_read_b128 v[140:143], v180 offset:24576
    s_waitcnt lgkmcnt(10)
    v_mfma_f32_16x16x32_bf16 v[192:195], v[96:99], v[116:119], v[192:195]
    ds_read_b128 v[144:147], v181 offset:4096
    v_mfma_f32_16x16x32_bf16 v[208:211], v[100:103], v[116:119], v[208:211]
    ds_read_b128 v[148:151], v181 offset:24576
    v_mfma_f32_16x16x32_bf16 v[224:227], v[104:107], v[116:119], v[224:227]
    s_waitcnt lgkmcnt(11)
    v_mfma_f32_16x16x32_bf16 v[196:199], v[96:99], v[120:123], v[196:199]
    v_mfma_f32_16x16x32_bf16 v[212:215], v[100:103], v[120:123], v[212:215]
    v_mfma_f32_16x16x32_bf16 v[228:231], v[104:107], v[120:123], v[228:231]
    s_waitcnt lgkmcnt(3)
    v_readfirstlane_b32 s64, v176
    s_cmp_ge_u32 s64, 4
    s_cbranch_scc1 L_ok_5
L_cw_6:
    ds_read_b32 v176, v15 offset:20
    s_add_u32 s41, s41, 1
    s_cmp_gt_u32 s41, 400000
    s_waitcnt lgkmcnt(0)
    s_cbranch_scc1 L_cwd_7
    v_readfirstlane_b32 s64, v176
    s_cmp_ge_u32 s64, 4
    s_cbranch_scc1 L_cwd_7
    s_branch L_cw_6
L_cwd_7:
    s_mov_b32 s41, 0
L_ok_5:
    v_mfma_f32_16x16x32_bf16 v[232:235], v[244:247], v[124:127], v[232:235]
    s_add_u32 m0, s38, 3072
    s_nop 0
    buffer_load_dwordx4 v5, s[12:15], s46 offen offset:0 lds
    v_mfma_f32_16x16x32_bf16 v[236:239], v[244:247], v[128:131], v[236:239]
    buffer_load_dwordx4 v6, s[12:15], s46 offen offset:1024 lds
    v_mfma_f32_16x16x32_bf16 v[240:243], v[244:247], v[132:135], v[240:243]
    buffer_load_dwordx4 v7, s[12:15], s46 offen offset:2048 lds
    s_add_u32 s46, s46, 98304
    s_cmp_eq_u32 s46, s47
    s_cselect_b32 s46, s37, s46
    v_mfma_f32_16x16x32_bf16 v[184:187], v[124:127], v[136:139], v[184:187]
    v_mfma_f32_16x16x32_bf16 v[200:203], v[128:131], v[136:139], v[200:203]
    ds_read_b128 v[108:111], v178 offset:6144
    v_mfma_f32_16x16x32_bf16 v[216:219], v[132:135], v[136:139], v[216:219]
    s_waitcnt vmcnt(9)
    ds_read_b64_tr_b16 v[96:97], v11 offset:6144
    ds_read_b64_tr_b16 v[98:99], v11 offset:7680
    s_waitcnt lgkmcnt(5)
    v_mfma_f32_16x16x32_bf16 v[188:191], v[124:127], v[140:143], v[188:191]
    ds_read_b64_tr_b16 v[100:101], v11 offset:6176
    ds_read_b64_tr_b16 v[102:103], v11 offset:7712
    v_mfma_f32_16x16x32_bf16 v[204:207], v[128:131], v[140:143], v[204:207]
    ds_read_b64_tr_b16 v[104:105], v11 offset:6208
    ds_read_b64_tr_b16 v[106:107], v11 offset:7744
    v_mfma_f32_16x16x32_bf16 v[220:223], v[132:135], v[140:143], v[220:223]
    ds_read_b128 v[112:115], v178 offset:26624
    s_waitcnt lgkmcnt(9)
    v_mfma_f32_16x16x32_bf16 v[192:195], v[124:127], v[144:147], v[192:195]
    ds_read_b128 v[116:119], v179 offset:6144
    v_mfma_f32_16x16x32_bf16 v[208:211], v[128:131], v[144:147], v[208:211]
    ds_read_b128 v[120:123], v179 offset:26624
    v_mfma_f32_16x16x32_bf16 v[224:227], v[132:135], v[144:147], v[224:227]
    ds_read_b128 v[16:19], v182 offset:0
    s_waitcnt lgkmcnt(11)
    v_mfma_f32_16x16x32_bf16 v[196:199], v[124:127], v[148:151], v[196:199]
    ds_read_b128 v[20:23], v182 offset:256
    v_mfma_f32_16x16x32_bf16 v[212:215], v[128:131], v[148:151], v[212:215]
    ds_read_b128 v[24:27], v182 offset:512
    v_mfma_f32_16x16x32_bf16 v[228:231], v[132:135], v[148:151], v[228:231]
    ds_read_b128 v[28:31], v182 offset:768
    s_waitcnt lgkmcnt(7)
    v_mfma_f32_16x16x32_bf16 v[232:235], v[244:247], v[96:99], v[232:235]
    s_add_u32 m0, s38, 6144
    s_nop 0
    buffer_load_dwordx4 v5, s[12:15], s46 offen offset:0 lds
    v_mfma_f32_16x16x32_bf16 v[236:239], v[244:247], v[100:103], v[236:239]
    buffer_load_dwordx4 v6, s[12:15], s46 offen offset:1024 lds
    v_mfma_f32_16x16x32_bf16 v[240:243], v[244:247], v[104:107], v[240:243]
    buffer_load_dwordx4 v7, s[12:15], s46 offen offset:2048 lds
    s_add_u32 s46, s46, 98304
    s_cmp_eq_u32 s46, s47
    s_cselect_b32 s46, s37, s46
    v_mfma_f32_16x16x32_bf16 v[184:187], v[96:99], v[108:111], v[184:187]
    buffer_load_dword v14, off, s[96:99], 0 sc1
    v_mfma_f32_16x16x32_bf16 v[200:203], v[100:103], v[108:111], v[200:203]
    ds_read_b128 v[136:139], v180 offset:6144
    v_mfma_f32_16x16x32_bf16 v[216:219], v[104:107], v[108:111], v[216:219]
    s_waitcnt vmcnt(10)
    ds_read_b64_tr_b16 v[124:125], v11 offset:9216
    ds_read_b64_tr_b16 v[126:127], v11 offset:10752
    s_waitcnt lgkmcnt(9)
    v_mfma_f32_16x16x32_bf16 v[188:191], v[96:99], v[112:115], v[188:191]
    ds_read_b64_tr_b16 v[128:129], v11 offset:9248
    ds_read_b64_tr_b16 v[130:131], v11 offset:10784
    v_mfma_f32_16x16x32_bf16 v[204:207], v[100:103], v[112:115], v[204:207]
    ds_read_b64_tr_b16 v[132:133], v11 offset:9280
    ds_read_b64_tr_b16 v[134:135], v11 offset:10816
    v_mfma_f32_16x16x32_bf16 v[220:223], v[104:107], v[112:115], v[220:223]
    ds_read_b128 v[140:143], v180 offset:26624
    s_waitcnt lgkmcnt(13)
    v_mfma_f32_16x16x32_bf16 v[192:195], v[96:99], v[116:119], v[192:195]
    ds_read_b128 v[144:147], v181 offset:6144
    v_mfma_f32_16x16x32_bf16 v[208:211], v[100:103], v[116:119], v[208:211]
    ds_read_b128 v[148:151], v181 offset:26624
    v_mfma_f32_16x16x32_bf16 v[224:227], v[104:107], v[116:119], v[224:227]
    s_waitcnt lgkmcnt(14)
    v_mfma_f32_16x16x32_bf16 v[196:199], v[96:99], v[120:123], v[196:199]
    v_mfma_f32_16x16x32_bf16 v[212:215], v[100:103], v[120:123], v[212:215]
    v_mfma_f32_16x16x32_bf16 v[228:231], v[104:107], v[120:123], v[228:231]
    s_waitcnt lgkmcnt(3)
    v_mfma_f32_16x16x32_bf16 v[232:235], v[244:247], v[124:127], v[232:235]
    s_add_u32 m0, s38, 9216
    s_nop 0
    buffer_load_dwordx4 v5, s[12:15], s46 offen offset:0 lds
    v_mfma_f32_16x16x32_bf16 v[236:239], v[244:247], v[128:131], v[236:239]
    buffer_load_dwordx4 v6, s[12:15], s46 offen offset:1024 lds
    v_mfma_f32_16x16x32_bf16 v[240:243], v[244:247], v[132:135], v[240:243]
    buffer_load_dwordx4 v7, s[12:15], s46 offen offset:2048 lds
    s_add_u32 s46, s46, 98304
    s_cmp_eq_u32 s46, s47
    s_cselect_b32 s46, s37, s46
    v_mfma_f32_16x16x32_bf16 v[184:187], v[124:127], v[136:139], v[184:187]
    v_mfma_f32_16x16x32_bf16 v[200:203], v[128:131], v[136:139], v[200:203]
    ds_read_b128 v[108:111], v178 offset:8192
    v_mfma_f32_16x16x32_bf16 v[216:219], v[132:135], v[136:139], v[216:219]
    s_waitcnt vmcnt(10)
    ds_read_b64_tr_b16 v[96:97], v11 offset:0
    ds_read_b64_tr_b16 v[98:99], v11 offset:1536
    s_waitcnt lgkmcnt(5)
    v_mfma_f32_16x16x32_bf16 v[188:191], v[124:127], v[140:143], v[188:191]
    ds_read_b64_tr_b16 v[100:101], v11 offset:32
    ds_read_b64_tr_b16 v[102:103], v11 offset:1568
    v_mfma_f32_16x16x32_bf16 v[204:207], v[128:131], v[140:143], v[204:207]
    ds_read_b64_tr_b16 v[104:105], v11 offset:64
    ds_read_b64_tr_b16 v[106:107], v11 offset:1600
    v_mfma_f32_16x16x32_bf16 v[220:223], v[132:135], v[140:143], v[220:223]
    ds_read_b128 v[112:115], v178 offset:28672
    s_waitcnt lgkmcnt(9)
    v_mfma_f32_16x16x32_bf16 v[192:195], v[124:127], v[144:147], v[192:195]
    ds_read_b128 v[116:119], v179 offset:8192
    v_mfma_f32_16x16x32_bf16 v[208:211], v[128:131], v[144:147], v[208:211]
    ds_read_b128 v[120:123], v179 offset:28672
    v_mfma_f32_16x16x32_bf16 v[224:227], v[132:135], v[144:147], v[224:227]
    buffer_load_ushort v52, v10, s[16:19], s48 offen
    s_waitcnt lgkmcnt(10)
    v_mfma_f32_16x16x32_bf16 v[196:199], v[124:127], v[148:151], v[196:199]
    buffer_load_ushort v53, v10, s[16:19], s48 offen offset:32
    v_mfma_f32_16x16x32_bf16 v[212:215], v[128:131], v[148:151], v[212:215]
    buffer_load_ushort v54, v10, s[16:19], s49 offen offset:64
    v_mfma_f32_16x16x32_bf16 v[228:231], v[132:135], v[148:151], v[228:231]
    s_setprio 0
    s_waitcnt lgkmcnt(3)
    v_mfma_f32_16x16x32_bf16 v[232:235], v[244:247], v[96:99], v[232:235]
    s_add_u32 m0, s38, 0
    s_nop 0
    buffer_load_dwordx4 v5, s[12:15], s46 offen offset:0 lds
    v_mfma_f32_16x16x32_bf16 v[236:239], v[244:247], v[100:103], v[236:239]
    buffer_load_dwordx4 v6, s[12:15], s46 offen offset:1024 lds
    v_mfma_f32_16x16x32_bf16 v[240:243], v[244:247], v[104:107], v[240:243]
    buffer_load_dwordx4 v7, s[12:15], s46 offen offset:2048 lds
    s_add_u32 s46, s46, 98304
    s_cmp_eq_u32 s46, s47
    s_cselect_b32 s46, s37, s46
    v_mfma_f32_16x16x32_bf16 v[184:187], v[96:99], v[108:111], v[184:187]
    v_mfma_f32_16x16x32_bf16 v[200:203], v[100:103], v[108:111], v[200:203]
    ds_read_b128 v[136:139], v180 offset:8192
    v_mfma_f32_16x16x32_bf16 v[216:219], v[104:107], v[108:111], v[216:219]
    s_waitcnt vmcnt(13)
    ds_read_b64_tr_b16 v[124:125], v11 offset:3072
    ds_read_b64_tr_b16 v[126:127], v11 offset:4608
    s_waitcnt lgkmcnt(5)
    v_mfma_f32_16x16x32_bf16 v[188:191], v[96:99], v[112:115], v[188:191]
    ds_read_b64_tr_b16 v[128:129], v11 offset:3104
    ds_read_b64_tr_b16 v[130:131], v11 offset:4640
    v_mfma_f32_16x16x32_bf16 v[204:207], v[100:103], v[112:115], v[204:207]
    ds_read_b64_tr_b16 v[132:133], v11 offset:3136
    ds_read_b64_tr_b16 v[134:135], v11 offset:4672
    v_mfma_f32_16x16x32_bf16 v[220:223], v[104:107], v[112:115], v[220:223]
    ds_read_b128 v[140:143], v180 offset:28672
    s_waitcnt lgkmcnt(9)
    v_mfma_f32_16x16x32_bf16 v[192:195], v[96:99], v[116:119], v[192:195]
    ds_read_b128 v[144:147], v181 offset:8192
    v_mfma_f32_16x16x32_bf16 v[208:211], v[100:103], v[116:119], v[208:211]
    ds_read_b128 v[148:151], v181 offset:28672
    v_mfma_f32_16x16x32_bf16 v[224:227], v[104:107], v[116:119], v[224:227]
    s_mul_i32 s36, s40, 3
    s_lshr_b32 s36, s36, 1
    s_waitcnt lgkmcnt(10)
    v_mfma_f32_16x16x32_bf16 v[196:199], v[96:99], v[120:123], v[196:199]
    s_mul_i32 s56, s34, 48
    s_mul_i32 s35, s39, 12
    v_mfma_f32_16x16x32_bf16 v[212:215], v[100:103], v[120:123], v[212:215]
    s_add_u32 s56, s56, s35
    s_mul_i32 s56, s56, 5120
    v_mfma_f32_16x16x32_bf16 v[228:231], v[104:107], v[120:123], v[228:231]
    s_mul_i32 s57, s36, 5120
    s_add_u32 s57, s57, s56
    s_waitcnt lgkmcnt(3)
    v_mfma_f32_16x16x32_bf16 v[232:235], v[244:247], v[124:127], v[232:235]
    s_add_u32 m0, s38, 3072
    s_nop 0
    buffer_load_dwordx4 v5, s[12:15], s46 offen offset:0 lds
    v_mfma_f32_16x16x32_bf16 v[236:239], v[244:247], v[128:131], v[236:239]
    buffer_load_dwordx4 v6, s[12:15], s46 offen offset:1024 lds
    v_mfma_f32_16x16x32_bf16 v[240:243], v[244:247], v[132:135], v[240:243]
    buffer_load_dwordx4 v7, s[12:15], s46 offen offset:2048 lds
    s_add_u32 s46, s46, 98304
    s_cmp_eq_u32 s46, s47
    s_cselect_b32 s46, s37, s46
    v_mfma_f32_16x16x32_bf16 v[184:187], v[124:127], v[136:139], v[184:187]
    v_mfma_f32_16x16x32_bf16 v[200:203], v[128:131], v[136:139], v[200:203]
    ds_read_b128 v[108:111], v178 offset:10240
    v_mfma_f32_16x16x32_bf16 v[216:219], v[132:135], v[136:139], v[216:219]
    s_waitcnt vmcnt(13)
    ds_read_b64_tr_b16 v[96:97], v11 offset:6144
    ds_read_b64_tr_b16 v[98:99], v11 offset:7680
    s_waitcnt lgkmcnt(5)
    v_mfma_f32_16x16x32_bf16 v[188:191], v[124:127], v[140:143], v[188:191]
    ds_read_b64_tr_b16 v[100:101], v11 offset:6176
    ds_read_b64_tr_b16 v[102:103], v11 offset:7712
    v_mfma_f32_16x16x32_bf16 v[204:207], v[128:131], v[140:143], v[204:207]
    ds_read_b64_tr_b16 v[104:105], v11 offset:6208
    ds_read_b64_tr_b16 v[106:107], v11 offset:7744
    v_mfma_f32_16x16x32_bf16 v[220:223], v[132:135], v[140:143], v[220:223]
    ds_read_b128 v[112:115], v178 offset:30720
    s_waitcnt lgkmcnt(9)
    v_mfma_f32_16x16x32_bf16 v[192:195], v[124:127], v[144:147], v[192:195]
    ds_read_b128 v[116:119], v179 offset:10240
    v_mfma_f32_16x16x32_bf16 v[208:211], v[128:131], v[144:147], v[208:211]
    ds_read_b128 v[120:123], v179 offset:30720
    v_mfma_f32_16x16x32_bf16 v[224:227], v[132:135], v[144:147], v[224:227]
    s_add_u32 s58, s56, 61440
    s_mul_i32 s59, s33, 192
    s_waitcnt lgkmcnt(10)
    v_mfma_f32_16x16x32_bf16 v[196:199], v[124:127], v[148:151], v[196:199]
    s_add_u32 s59, s59, s35
    s_lshl_b32 s59, s59, 10
    v_mfma_f32_16x16x32_bf16 v[212:215], v[128:131], v[148:151], v[212:215]
    s_lshl_b32 s60, s36, 10
    s_add_u32 s60, s60, s59
    v_mfma_f32_16x16x32_bf16 v[228:231], v[132:135], v[148:151], v[228:231]
    s_add_u32 s61, s59, 12288
    v_lshlrev_b32 v8, 4, v1
    s_waitcnt lgkmcnt(3)
    v_mfma_f32_16x16x32_bf16 v[232:235], v[244:247], v[96:99], v[232:235]
    s_add_u32 m0, s38, 6144
    s_nop 0
    buffer_load_dwordx4 v5, s[12:15], s46 offen offset:0 lds
    v_mfma_f32_16x16x32_bf16 v[236:239], v[244:247], v[100:103], v[236:239]
    buffer_load_dwordx4 v6, s[12:15], s46 offen offset:1024 lds
    v_mfma_f32_16x16x32_bf16 v[240:243], v[244:247], v[104:107], v[240:243]
    buffer_load_dwordx4 v7, s[12:15], s46 offen offset:2048 lds
    s_add_u32 s46, s46, 98304
    s_cmp_eq_u32 s46, s47
    s_cselect_b32 s46, s37, s46
    v_mfma_f32_16x16x32_bf16 v[184:187], v[96:99], v[108:111], v[184:187]
    v_mfma_f32_16x16x32_bf16 v[200:203], v[100:103], v[108:111], v[200:203]
    ds_read_b128 v[136:139], v180 offset:10240
    v_mfma_f32_16x16x32_bf16 v[216:219], v[104:107], v[108:111], v[216:219]
    s_waitcnt vmcnt(12)
    ds_read_b64_tr_b16 v[124:125], v11 offset:9216
    ds_read_b64_tr_b16 v[126:127], v11 offset:10752
    s_waitcnt lgkmcnt(5)
    v_mfma_f32_16x16x32_bf16 v[188:191], v[96:99], v[112:115], v[188:191]
    ds_read_b64_tr_b16 v[128:129], v11 offset:9248
    ds_read_b64_tr_b16 v[130:131], v11 offset:10784
    v_mfma_f32_16x16x32_bf16 v[204:207], v[100:103], v[112:115], v[204:207]
    ds_read_b64_tr_b16 v[132:133], v11 offset:9280
    ds_read_b64_tr_b16 v[134:135], v11 offset:10816
    v_mfma_f32_16x16x32_bf16 v[220:223], v[104:107], v[112:115], v[220:223]
    ds_read_b128 v[140:143], v180 offset:30720
    s_waitcnt lgkmcnt(9)
    v_mfma_f32_16x16x32_bf16 v[192:195], v[96:99], v[116:119], v[192:195]
    ds_read_b128 v[144:147], v181 offset:10240
    v_mfma_f32_16x16x32_bf16 v[208:211], v[100:103], v[116:119], v[208:211]
    ds_read_b128 v[148:151], v181 offset:30720
    v_mfma_f32_16x16x32_bf16 v[224:227], v[104:107], v[116:119], v[224:227]
    v_add_u32 v9, 4096, v8
    s_mul_i32 s52, s33, 192
    s_waitcnt lgkmcnt(10)
    v_mfma_f32_16x16x32_bf16 v[196:199], v[96:99], v[120:123], v[196:199]
    s_mul_i32 s53, s34, 6
    s_add_u32 s52, s52, s53
    v_mfma_f32_16x16x32_bf16 v[212:215], v[100:103], v[120:123], v[212:215]
    s_lshr_b32 s53, s39, 1
    s_mul_i32 s53, s53, 3
    v_mfma_f32_16x16x32_bf16 v[228:231], v[104:107], v[120:123], v[228:231]
    s_add_u32 s52, s52, s53
    s_and_b32 s53, s39, 1
    s_waitcnt lgkmcnt(3)
    v_mfma_f32_16x16x32_bf16 v[232:235], v[244:247], v[124:127], v[232:235]
    s_add_u32 m0, s38, 9216
    s_nop 0
    buffer_load_dwordx4 v5, s[12:15], s46 offen offset:0 lds
    v_mfma_f32_16x16x32_bf16 v[236:239], v[244:247], v[128:131], v[236:239]
    buffer_load_dwordx4 v6, s[12:15], s46 offen offset:1024 lds
    v_mfma_f32_16x16x32_bf16 v[240:243], v[244:247], v[132:135], v[240:243]
    buffer_load_dwordx4 v7, s[12:15], s46 offen offset:2048 lds
    s_add_u32 s46, s46, 98304
    s_cmp_eq_u32 s46, s47
    s_cselect_b32 s46, s37, s46
    v_mfma_f32_16x16x32_bf16 v[184:187], v[124:127], v[136:139], v[184:187]
    v_mfma_f32_16x16x32_bf16 v[200:203], v[128:131], v[136:139], v[200:203]
    ds_read_b128 v[108:111], v178 offset:12288
    v_mfma_f32_16x16x32_bf16 v[216:219], v[132:135], v[136:139], v[216:219]
    s_waitcnt vmcnt(9)
    ds_read_b64_tr_b16 v[96:97], v11 offset:0
    ds_read_b64_tr_b16 v[98:99], v11 offset:1536
    s_waitcnt lgkmcnt(5)
    v_mfma_f32_16x16x32_bf16 v[188:191], v[124:127], v[140:143], v[188:191]
    ds_read_b64_tr_b16 v[100:101], v11 offset:32
    ds_read_b64_tr_b16 v[102:103], v11 offset:1568
    v_mfma_f32_16x16x32_bf16 v[204:207], v[128:131], v[140:143], v[204:207]
    ds_read_b64_tr_b16 v[104:105], v11 offset:64
    ds_read_b64_tr_b16 v[106:107], v11 offset:1600
    v_mfma_f32_16x16x32_bf16 v[220:223], v[132:135], v[140:143], v[220:223]
    ds_read_b128 v[112:115], v178 offset:32768
    s_waitcnt lgkmcnt(9)
    v_mfma_f32_16x16x32_bf16 v[192:195], v[124:127], v[144:147], v[192:195]
    ds_read_b128 v[116:119], v179 offset:12288
    v_mfma_f32_16x16x32_bf16 v[208:211], v[128:131], v[144:147], v[208:211]
    ds_read_b128 v[120:123], v179 offset:32768
    v_mfma_f32_16x16x32_bf16 v[224:227], v[132:135], v[144:147], v[224:227]
    s_add_u32 s54, s52, s53
    s_lshl_b32 s54, s54, 10
    s_waitcnt lgkmcnt(10)
    v_mfma_f32_16x16x32_bf16 v[196:199], v[124:127], v[148:151], v[196:199]
    s_add_u32 s52, s52, 2
    s_lshl_b32 s52, s52, 10
    v_mfma_f32_16x16x32_bf16 v[212:215], v[128:131], v[148:151], v[212:215]
    s_lshl_b32 s53, s53, 9
    s_add_u32 s52, s52, s53
    v_mfma_f32_16x16x32_bf16 v[228:231], v[132:135], v[148:151], v[228:231]
    v_and_b32 v4, 1, v12
    v_mul_u32_u24 v4, 49152, v4
    s_waitcnt lgkmcnt(3)
    s_buffer_load_dwordx16 s[64:79], s[28:31], s62 offset:64 glc
    v_mfma_f32_16x16x32_bf16 v[232:235], v[244:247], v[96:99], v[232:235]
    s_add_u32 m0, s38, 0
    s_nop 0
    buffer_load_dwordx4 v5, s[12:15], s46 offen offset:0 lds
    v_mfma_f32_16x16x32_bf16 v[236:239], v[244:247], v[100:103], v[236:239]
    buffer_load_dwordx4 v6, s[12:15], s46 offen offset:1024 lds
    v_mfma_f32_16x16x32_bf16 v[240:243], v[244:247], v[104:107], v[240:243]
    buffer_load_dwordx4 v7, s[12:15], s46 offen offset:2048 lds
    s_add_u32 s46, s46, 98304
    s_cmp_eq_u32 s46, s47
    s_cselect_b32 s46, s37, s46
    v_mfma_f32_16x16x32_bf16 v[184:187], v[96:99], v[108:111], v[184:187]
    v_mfma_f32_16x16x32_bf16 v[200:203], v[100:103], v[108:111], v[200:203]
    ds_read_b128 v[136:139], v180 offset:12288
    v_mfma_f32_16x16x32_bf16 v[216:219], v[104:107], v[108:111], v[216:219]
    s_waitcnt vmcnt(9)
    ds_read_b64_tr_b16 v[124:125], v11 offset:3072
    ds_read_b64_tr_b16 v[126:127], v11 offset:4608
    s_waitcnt lgkmcnt(5)
    v_mfma_f32_16x16x32_bf16 v[188:191], v[96:99], v[112:115], v[188:191]
    ds_read_b64_tr_b16 v[128:129], v11 offset:3104
    ds_read_b64_tr_b16 v[130:131], v11 offset:4640
    v_mfma_f32_16x16x32_bf16 v[204:207], v[100:103], v[112:115], v[204:207]
    ds_read_b64_tr_b16 v[132:133], v11 offset:3136
    ds_read_b64_tr_b16 v[134:135], v11 offset:4672
    v_mfma_f32_16x16x32_bf16 v[220:223], v[104:107], v[112:115], v[220:223]
    ds_read_b128 v[140:143], v180 offset:32768
    s_waitcnt lgkmcnt(9)
    v_mfma_f32_16x16x32_bf16 v[192:195], v[96:99], v[116:119], v[192:195]
    ds_read_b128 v[144:147], v181 offset:12288
    v_mfma_f32_16x16x32_bf16 v[208:211], v[100:103], v[116:119], v[208:211]
    ds_read_b128 v[148:151], v181 offset:32768
    v_mfma_f32_16x16x32_bf16 v[224:227], v[104:107], v[116:119], v[224:227]
    v_lshrrev_b32 v2, 1, v12
    v_lshl_add_u32 v4, v2, 8, v4
    s_waitcnt lgkmcnt(10)
    v_mfma_f32_16x16x32_bf16 v[196:199], v[96:99], v[120:123], v[196:199]
    v_and_b32 v2, 15, v1
    v_lshl_add_u32 v4, v2, 4, v4
    v_mfma_f32_16x16x32_bf16 v[212:215], v[100:103], v[120:123], v[212:215]
    s_mov_b32 s48, 0xbdd2d3e8
    v_mov_b32 v10, 0xc0135761
    v_mfma_f32_16x16x32_bf16 v[228:231], v[104:107], v[120:123], v[228:231]
    s_waitcnt lgkmcnt(3)
    v_mfma_f32_16x16x32_bf16 v[232:235], v[244:247], v[124:127], v[232:235]
    s_add_u32 m0, s38, 3072
    s_nop 0
    buffer_load_dwordx4 v5, s[12:15], s46 offen offset:0 lds
    v_mfma_f32_16x16x32_bf16 v[236:239], v[244:247], v[128:131], v[236:239]
    buffer_load_dwordx4 v6, s[12:15], s46 offen offset:1024 lds
    v_mfma_f32_16x16x32_bf16 v[240:243], v[244:247], v[132:135], v[240:243]
    buffer_load_dwordx4 v7, s[12:15], s46 offen offset:2048 lds
    s_add_u32 s46, s46, 98304
    s_cmp_eq_u32 s46, s47
    s_cselect_b32 s46, s37, s46
    v_mfma_f32_16x16x32_bf16 v[184:187], v[124:127], v[136:139], v[184:187]
    v_mfma_f32_16x16x32_bf16 v[200:203], v[128:131], v[136:139], v[200:203]
    ds_read_b128 v[108:111], v178 offset:14336
    v_mfma_f32_16x16x32_bf16 v[216:219], v[132:135], v[136:139], v[216:219]
    s_waitcnt vmcnt(9)
    ds_read_b64_tr_b16 v[96:97], v11 offset:6144
    ds_read_b64_tr_b16 v[98:99], v11 offset:7680
    s_waitcnt lgkmcnt(5)
    v_mfma_f32_16x16x32_bf16 v[188:191], v[124:127], v[140:143], v[188:191]
    ds_read_b64_tr_b16 v[100:101], v11 offset:6176
    ds_read_b64_tr_b16 v[102:103], v11 offset:7712
    v_mfma_f32_16x16x32_bf16 v[204:207], v[128:131], v[140:143], v[204:207]
    ds_read_b64_tr_b16 v[104:105], v11 offset:6208
    ds_read_b64_tr_b16 v[106:107], v11 offset:7744
    v_mfma_f32_16x16x32_bf16 v[220:223], v[132:135], v[140:143], v[220:223]
    ds_read_b128 v[112:115], v178 offset:34816
    s_waitcnt lgkmcnt(9)
    v_mfma_f32_16x16x32_bf16 v[192:195], v[124:127], v[144:147], v[192:195]
    ds_read_b128 v[116:119], v179 offset:14336
    v_mfma_f32_16x16x32_bf16 v[208:211], v[128:131], v[144:147], v[208:211]
    ds_read_b128 v[120:123], v179 offset:34816
    v_mfma_f32_16x16x32_bf16 v[224:227], v[132:135], v[144:147], v[224:227]
    s_waitcnt lgkmcnt(10)
    v_mfma_f32_16x16x32_bf16 v[196:199], v[124:127], v[148:151], v[196:199]
    v_mfma_f32_16x16x32_bf16 v[212:215], v[128:131], v[148:151], v[212:215]
    v_mfma_f32_16x16x32_bf16 v[228:231], v[132:135], v[148:151], v[228:231]
    s_waitcnt lgkmcnt(3)
    v_mfma_f32_16x16x32_bf16 v[232:235], v[244:247], v[96:99], v[232:235]
    s_add_u32 m0, s38, 6144
    s_nop 0
    buffer_load_dwordx4 v5, s[12:15], s46 offen offset:0 lds
    v_mfma_f32_16x16x32_bf16 v[236:239], v[244:247], v[100:103], v[236:239]
    buffer_load_dwordx4 v6, s[12:15], s46 offen offset:1024 lds
    v_mfma_f32_16x16x32_bf16 v[240:243], v[244:247], v[104:107], v[240:243]
    buffer_load_dwordx4 v7, s[12:15], s46 offen offset:2048 lds
    s_add_u32 s46, s46, 98304
    s_cmp_eq_u32 s46, s47
    s_cselect_b32 s46, s37, s46
    v_mfma_f32_16x16x32_bf16 v[184:187], v[96:99], v[108:111], v[184:187]
    v_lshlrev_b32 v52, 16, v52
    v_lshlrev_b32 v53, 16, v53
    v_lshlrev_b32 v54, 16, v54
    v_mfma_f32_16x16x32_bf16 v[200:203], v[100:103], v[108:111], v[200:203]
    ds_read_b128 v[136:139], v180 offset:14336
    v_mfma_f32_16x16x32_bf16 v[216:219], v[104:107], v[108:111], v[216:219]
    s_waitcnt vmcnt(9)
    ds_read_b64_tr_b16 v[124:125], v11 offset:9216
    ds_read_b64_tr_b16 v[126:127], v11 offset:10752
    s_waitcnt lgkmcnt(5)
    v_mfma_f32_16x16x32_bf16 v[188:191], v[96:99], v[112:115], v[188:191]
    ds_read_b64_tr_b16 v[128:129], v11 offset:9248
    ds_read_b64_tr_b16 v[130:131], v11 offset:10784
    v_mfma_f32_16x16x32_bf16 v[204:207], v[100:103], v[112:115], v[204:207]
    ds_read_b64_tr_b16 v[132:133], v11 offset:9280
    ds_read_b64_tr_b16 v[134:135], v11 offset:10816
    v_mfma_f32_16x16x32_bf16 v[220:223], v[104:107], v[112:115], v[220:223]
    ds_read_b128 v[140:143], v180 offset:34816
    s_waitcnt lgkmcnt(9)
    v_mfma_f32_16x16x32_bf16 v[192:195], v[96:99], v[116:119], v[192:195]
    ds_read_b128 v[144:147], v181 offset:14336
    v_mfma_f32_16x16x32_bf16 v[208:211], v[100:103], v[116:119], v[208:211]
    ds_read_b128 v[148:151], v181 offset:34816
    v_mfma_f32_16x16x32_bf16 v[224:227], v[104:107], v[116:119], v[224:227]
    s_waitcnt lgkmcnt(10)
    v_mfma_f32_16x16x32_bf16 v[196:199], v[96:99], v[120:123], v[196:199]
    v_mfma_f32_16x16x32_bf16 v[212:215], v[100:103], v[120:123], v[212:215]
    v_mfma_f32_16x16x32_bf16 v[228:231], v[104:107], v[120:123], v[228:231]
    s_waitcnt lgkmcnt(3)
    v_mfma_f32_16x16x32_bf16 v[232:235], v[244:247], v[124:127], v[232:235]
    s_add_u32 m0, s38, 9216
    s_nop 0
    buffer_load_dwordx4 v5, s[12:15], s46 offen offset:0 lds
    v_mfma_f32_16x16x32_bf16 v[236:239], v[244:247], v[128:131], v[236:239]
    buffer_load_dwordx4 v6, s[12:15], s46 offen offset:1024 lds
    v_mfma_f32_16x16x32_bf16 v[240:243], v[244:247], v[132:135], v[240:243]
    buffer_load_dwordx4 v7, s[12:15], s46 offen offset:2048 lds
    s_add_u32 s46, s46, 98304
    s_cmp_eq_u32 s46, s47
    s_cselect_b32 s46, s37, s46
    v_mfma_f32_16x16x32_bf16 v[184:187], v[124:127], v[136:139], v[184:187]
    v_and_b32 v248, s44, v17
    v_mul_f32 v32, v18, v18
    v_mfma_f32_16x16x32_bf16 v[200:203], v[128:131], v[136:139], v[200:203]
    ds_read_b128 v[108:111], v178 offset:16384
    v_mfma_f32_16x16x32_bf16 v[216:219], v[132:135], v[136:139], v[216:219]
    s_waitcnt vmcnt(9)
    ds_read_b64_tr_b16 v[96:97], v11 offset:0
    ds_read_b64_tr_b16 v[98:99], v11 offset:1536
    s_waitcnt lgkmcnt(5)
    v_mfma_f32_16x16x32_bf16 v[188:191], v[124:127], v[140:143], v[188:191]
    ds_read_b64_tr_b16 v[100:101], v11 offset:32
    ds_read_b64_tr_b16 v[102:103], v11 offset:1568
    v_mfma_f32_16x16x32_bf16 v[204:207], v[128:131], v[140:143], v[204:207]
    ds_read_b64_tr_b16 v[104:105], v11 offset:64
    ds_read_b64_tr_b16 v[106:107], v11 offset:1600
    v_mfma_f32_16x16x32_bf16 v[220:223], v[132:135], v[140:143], v[220:223]
    ds_read_b128 v[112:115], v178 offset:36864
    s_waitcnt lgkmcnt(9)
    v_mfma_f32_16x16x32_bf16 v[192:195], v[124:127], v[144:147], v[192:195]
    ds_read_b128 v[116:119], v179 offset:16384
    v_mfma_f32_16x16x32_bf16 v[208:211], v[128:131], v[144:147], v[208:211]
    ds_read_b128 v[120:123], v179 offset:36864
    v_mfma_f32_16x16x32_bf16 v[224:227], v[132:135], v[144:147], v[224:227]
    v_mul_f32 v33, 0xc0135761, v18
    v_mul_f32 v32, 0x3d372713, v32
    s_waitcnt lgkmcnt(10)
    v_mfma_f32_16x16x32_bf16 v[196:199], v[124:127], v[148:151], v[196:199]
    v_cndmask_b32 v16, 0, v16, s[50:51]
    v_mul_f32 v32, v32, v33
    v_mfma_f32_16x16x32_bf16 v[212:215], v[128:131], v[148:151], v[212:215]
    v_cndmask_b32 v17, 0, v17, s[50:51]
    v_mov_b32 v18, 0
    v_mov_b32 v19, 0
    v_mfma_f32_16x16x32_bf16 v[228:231], v[132:135], v[148:151], v[228:231]
    s_waitcnt lgkmcnt(3)
L_tok_8:
    v_readfirstlane_b32 s80, v14
    s_add_u32 s41, s41, 1
    s_cmp_lg_u32 s80, 0
    s_cbranch_scc1 L_tokd_9
    s_cmp_gt_u32 s41, 50000
    s_cbranch_scc1 L_tokd_9
    s_sleep 2
    buffer_load_dword v14, off, s[96:99], 0 sc1
    s_waitcnt vmcnt(0)
    s_branch L_tok_8
L_tokd_9:
    s_mov_b32 s81, s80
    s_branch L_poll_10_g
L_poll_10:
    s_buffer_load_dwordx16 s[64:79], s[28:31], s62 offset:64 glc
L_poll_10_g:
    s_add_u32 s41, s41, 1
    s_cmp_gt_u32 s41, 50000
    s_waitcnt lgkmcnt(0)
    s_cbranch_scc1 L_polld_11
    s_xor_b64 s[64:65], s[64:65], s[80:81]
    s_xor_b64 s[66:67], s[66:67], s[80:81]
    s_xor_b64 s[68:69], s[68:69], s[80:81]
    s_xor_b64 s[70:71], s[70:71], s[80:81]
    s_xor_b64 s[72:73], s[72:73], s[80:81]
    s_xor_b64 s[74:75], s[74:75], s[80:81]
    s_or_b64 s[64:65], s[64:65], s[66:67]
    s_or_b64 s[64:65], s[64:65], s[68:69]
    s_or_b64 s[64:65], s[64:65], s[70:71]
    s_or_b64 s[64:65], s[64:65], s[72:73]
    s_or_b64 s[64:65], s[64:65], s[74:75]
    s_cbranch_scc1 L_poll_10
L_polld_11:
    v_mfma_f32_16x16x32_bf16 v[232:235], v[244:247], v[96:99], v[232:235]
    buffer_load_dwordx4 v[56:59], v8, s[24:27], s57 offen offset:0 sc1
    v_mfma_f32_16x16x32_bf16 v[236:239], v[244:247], v[100:103], v[236:239]
    buffer_load_dwordx4 v[60:63], v8, s[24:27], s57 offen offset:1024 sc1
    v_mfma_f32_16x16x32_bf16 v[240:243], v[244:247], v[104:107], v[240:243]
    buffer_load_dwordx4 v[64:67], v8, s[24:27], s57 offen offset:2048 sc1
    v_mfma_f32_16x16x32_bf16 v[184:187], v[96:99], v[108:111], v[184:187]
    v_and_b32 v250, s44, v21
    v_mul_f32 v34, v22, v22
    v_mfma_f32_16x16x32_bf16 v[200:203], v[100:103], v[108:111], v[200:203]
    ds_read_b128 v[136:139], v180 offset:16384
    v_mfma_f32_16x16x32_bf16 v[216:219], v[104:107], v[108:111], v[216:219]
    s_waitcnt vmcnt(9)
    ds_read_b64_tr_b16 v[124:125], v11 offset:3072
    ds_read_b64_tr_b16 v[126:127], v11 offset:4608
    v_mfma_f32_16x16x32_bf16 v[188:191], v[96:99], v[112:115], v[188:191]
    ds_read_b64_tr_b16 v[128:129], v11 offset:3104
    ds_read_b64_tr_b16 v[130:131], v11 offset:4640
    v_mfma_f32_16x16x32_bf16 v[204:207], v[100:103], v[112:115], v[204:207]
    ds_read_b64_tr_b16 v[132:133], v11 offset:3136
    ds_read_b64_tr_b16 v[134:135], v11 offset:4672
    v_mfma_f32_16x16x32_bf16 v[220:223], v[104:107], v[112:115], v[220:223]
    ds_read_b128 v[140:143], v180 offset:36864
    v_mfma_f32_16x16x32_bf16 v[192:195], v[96:99], v[116:119], v[192:195]
    ds_read_b128 v[144:147], v181 offset:16384
    v_mfma_f32_16x16x32_bf16 v[208:211], v[100:103], v[116:119], v[208:211]
    ds_read_b128 v[148:151], v181 offset:36864
    v_mfma_f32_16x16x32_bf16 v[224:227], v[104:107], v[116:119], v[224:227]
    v_mul_f32 v35, 0xc0135761, v22
    v_mul_f32 v34, 0x3d372713, v34
    v_mfma_f32_16x16x32_bf16 v[196:199], v[96:99], v[120:123], v[196:199]
    buffer_load_dwordx4 v[68:71], v8, s[24:27], s57 offen offset:3072 sc1
    v_cndmask_b32 v20, 0, v20, s[50:51]
    v_mul_f32 v34, v34, v35
    v_mfma_f32_16x16x32_bf16 v[212:215], v[100:103], v[120:123], v[212:215]
    v_cndmask_b32 v21, 0, v21, s[50:51]
    v_mov_b32 v22, 0
    v_mov_b32 v23, 0
    v_mfma_f32_16x16x32_bf16 v[228:231], v[104:107], v[120:123], v[228:231]
    buffer_load_dwordx4 v[72:75], v9, s[24:27], s57 offen offset:0 sc1
    s_add_u32 s57, s57, 5120
    s_cmp_eq_u32 s57, s58
    s_cselect_b32 s57, s56, s57
    s_waitcnt lgkmcnt(3)
    v_mfma_f32_16x16x32_bf16 v[232:235], v[244:247], v[124:127], v[232:235]
    buffer_load_dwordx4 v[76:79], v8, s[24:27], s57 offen offset:0 sc1
    v_mfma_f32_16x16x32_bf16 v[236:239], v[244:247], v[128:131], v[236:239]
    buffer_load_dwordx4 v[80:83], v8, s[24:27], s57 offen offset:1024 sc1
    v_mfma_f32_16x16x32_bf16 v[240:243], v[244:247], v[132:135], v[240:243]
    buffer_load_dwordx4 v[84:87], v8, s[24:27], s57 offen offset:2048 sc1
    v_mfma_f32_16x16x32_bf16 v[184:187], v[124:127], v[136:139], v[184:187]
    v_and_b32 v252, s44, v25
    v_mul_f32 v36, v26, v26
    v_mfma_f32_16x16x32_bf16 v[200:203], v[128:131], v[136:139], v[200:203]
    ds_read_b128 v[108:111], v178 offset:18432
    v_mfma_f32_16x16x32_bf16 v[216:219], v[132:135], v[136:139], v[216:219]
    s_waitcnt vmcnt(11)
    ds_read_b64_tr_b16 v[96:97], v11 offset:6144
    ds_read_b64_tr_b16 v[98:99], v11 offset:7680
    s_waitcnt lgkmcnt(5)
    v_mfma_f32_16x16x32_bf16 v[188:191], v[124:127], v[140:143], v[188:191]
    ds_read_b64_tr_b16 v[100:101], v11 offset:6176
    ds_read_b64_tr_b16 v[102:103], v11 offset:7712
    v_mfma_f32_16x16x32_bf16 v[204:207], v[128:131], v[140:143], v[204:207]
    ds_read_b64_tr_b16 v[104:105], v11 offset:6208
    ds_read_b64_tr_b16 v[106:107], v11 offset:7744
    v_mfma_f32_16x16x32_bf16 v[220:223], v[132:135], v[140:143], v[220:223]
    ds_read_b128 v[112:115], v178 offset:38912
    s_waitcnt lgkmcnt(9)
    v_mfma_f32_16x16x32_bf16 v[192:195], v[124:127], v[144:147], v[192:195]
    ds_read_b128 v[116:119], v179 offset:18432
    v_mfma_f32_16x16x32_bf16 v[208:211], v[128:131], v[144:147], v[208:211]
    ds_read_b128 v[120:123], v179 offset:38912
    v_mfma_f32_16x16x32_bf16 v[224:227], v[132:135], v[144:147], v[224:227]
    v_mul_f32 v37, 0xc0135761, v26
    v_mul_f32 v36, 0x3d372713, v36
    s_waitcnt lgkmcnt(10)
    v_mfma_f32_16x16x32_bf16 v[196:199], v[124:127], v[148:151], v[196:199]
    buffer_load_dwordx4 v[88:91], v8, s[24:27], s57 offen offset:3072 sc1
    v_cndmask_b32 v24, 0, v24, s[50:51]
    v_mul_f32 v36, v36, v37
    v_mfma_f32_16x16x32_bf16 v[212:215], v[128:131], v[148:151], v[212:215]
    v_cndmask_b32 v25, 0, v25, s[50:51]
    v_mov_b32 v26, 0
    v_mov_b32 v27, 0
    v_mfma_f32_16x16x32_bf16 v[228:231], v[132:135], v[148:151], v[228:231]
    buffer_load_dwordx4 v[92:95], v9, s[24:27], s57 offen offset:0 sc1
    s_add_u32 s57, s57, 5120
    s_cmp_eq_u32 s57, s58
    s_cselect_b32 s57, s56, s57
    s_waitcnt lgkmcnt(3)
    v_mfma_f32_16x16x32_bf16 v[232:235], v[244:247], v[96:99], v[232:235]
    v_mfma_f32_16x16x32_bf16 v[236:239], v[244:247], v[100:103], v[236:239]
    v_mfma_f32_16x16x32_bf16 v[240:243], v[244:247], v[104:107], v[240:243]
    v_mfma_f32_16x16x32_bf16 v[184:187], v[96:99], v[108:111], v[184:187]
    v_and_b32 v254, s44, v29
    v_mul_f32 v38, v30, v30
    v_mfma_f32_16x16x32_bf16 v[200:203], v[100:103], v[108:111], v[200:203]
    ds_read_b128 v[136:139], v180 offset:18432
    v_mfma_f32_16x16x32_bf16 v[216:219], v[104:107], v[108:111], v[216:219]
    s_waitcnt vmcnt(10)
    ds_read_b64_tr_b16 v[124:125], v11 offset:9216
    ds_read_b64_tr_b16 v[126:127], v11 offset:10752
    s_waitcnt lgkmcnt(5)
    v_mfma_f32_16x16x32_bf16 v[188:191], v[96:99], v[112:115], v[188:191]
    ds_read_b64_tr_b16 v[128:129], v11 offset:9248
    ds_read_b64_tr_b16 v[130:131], v11 offset:10784
    v_mfma_f32_16x16x32_bf16 v[204:207], v[100:103], v[112:115], v[204:207]
    ds_read_b64_tr_b16 v[132:133], v11 offset:9280
    ds_read_b64_tr_b16 v[134:135], v11 offset:10816
    v_mfma_f32_16x16x32_bf16 v[220:223], v[104:107], v[112:115], v[220:223]
    ds_read_b128 v[140:143], v180 offset:38912
    s_waitcnt lgkmcnt(9)
    v_mfma_f32_16x16x32_bf16 v[192:195], v[96:99], v[116:119], v[192:195]
    ds_read_b128 v[144:147], v181 offset:18432
    v_mfma_f32_16x16x32_bf16 v[208:211], v[100:103], v[116:119], v[208:211]
    ds_read_b128 v[148:151], v181 offset:38912
    v_mfma_f32_16x16x32_bf16 v[224:227], v[104:107], v[116:119], v[224:227]
    v_mul_f32 v39, 0xc0135761, v30
    v_mul_f32 v38, 0x3d372713, v38
    s_waitcnt lgkmcnt(10)
    v_mfma_f32_16x16x32_bf16 v[196:199], v[96:99], v[120:123], v[196:199]
    v_cndmask_b32 v28, 0, v28, s[50:51]
    v_mul_f32 v38, v38, v39
    v_mfma_f32_16x16x32_bf16 v[212:215], v[100:103], v[120:123], v[212:215]
    v_cndmask_b32 v29, 0, v29, s[50:51]
    v_mov_b32 v30, 0
    v_mov_b32 v31, 0
    v_mfma_f32_16x16x32_bf16 v[228:231], v[104:107], v[120:123], v[228:231]
    s_waitcnt lgkmcnt(3)
    v_mfma_f32_16x16x32_bf16 v[232:235], v[244:247], v[124:127], v[232:235]
    v_mfma_f32_16x16x32_bf16 v[236:239], v[244:247], v[128:131], v[236:239]
    v_mfma_f32_16x16x32_bf16 v[240:243], v[244:247], v[132:135], v[240:243]
    v_mfma_f32_16x16x32_bf16 v[184:187], v[124:127], v[136:139], v[184:187]
    v_mfma_f32_16x16x32_bf16 v[200:203], v[128:131], v[136:139], v[200:203]
    v_mfma_f32_16x16x32_bf16 v[216:219], v[132:135], v[136:139], v[216:219]
    s_waitcnt lgkmcnt(2)
    v_mfma_f32_16x16x32_bf16 v[188:191], v[124:127], v[140:143], v[188:191]
    v_mfma_f32_16x16x32_bf16 v[204:207], v[128:131], v[140:143], v[204:207]
    v_mfma_f32_16x16x32_bf16 v[220:223], v[132:135], v[140:143], v[220:223]
    s_waitcnt lgkmcnt(1)
    v_mfma_f32_16x16x32_bf16 v[192:195], v[124:127], v[144:147], v[192:195]
    v_mfma_f32_16x16x32_bf16 v[208:211], v[128:131], v[144:147], v[208:211]
    v_cvt_pk_bf16_f32 v233, v232, v232
    v_cvt_pk_bf16_f32 v237, v236, v236
    v_mfma_f32_16x16x32_bf16 v[224:227], v[132:135], v[144:147], v[224:227]
    v_cvt_pk_bf16_f32 v241, v240, v240
    v_lshlrev_b32 v233, 16, v233
    s_waitcnt lgkmcnt(0)
    v_mfma_f32_16x16x32_bf16 v[196:199], v[124:127], v[148:151], v[196:199]
    v_lshlrev_b32 v237, 16, v237
    v_lshlrev_b32 v241, 16, v241
    v_mfma_f32_16x16x32_bf16 v[212:215], v[128:131], v[148:151], v[212:215]
    v_sub_f32 v233, v232, v233
    v_sub_f32 v237, v236, v237
    v_mfma_f32_16x16x32_bf16 v[228:231], v[132:135], v[148:151], v[228:231]
    v_sub_f32 v241, v240, v241
    v_cvt_pk_bf16_f32 v40, v232, v233
    s_setprio 2
    v_mov_b32 v13, 1
    s_lshl_b32 s35, s39, 2
    v_add_u32 v11, s35, v15
    s_mov_b64 exec, 1
    ds_add_u32 v15, v13 offset:8
    ds_add_u32 v11, v13 offset:32
    s_mov_b64 exec, -1
    v_cvt_pk_bf16_f32 v44, v236, v237
    v_cvt_pk_bf16_f32 v48, v240, v241
    v_and_b32 v234, s44, v40
    v_and_b32 v238, s44, v44
    v_and_b32 v242, s44, v48
    v_sub_f32 v233, v233, v234
    v_sub_f32 v237, v237, v238
    v_sub_f32 v241, v241, v242
    v_cvt_pk_bf16_f32 v41, v233, v52
    v_cvt_pk_bf16_f32 v45, v237, v53
    v_cvt_pk_bf16_f32 v49, v241, v54
    s_nop 1
    v_mfma_f32_16x16x32_bf16 v[184:187], v[40:43], v[16:19], v[184:187]
    v_mfma_f32_16x16x32_bf16 v[200:203], v[44:47], v[16:19], v[200:203]
    v_mfma_f32_16x16x32_bf16 v[216:219], v[48:51], v[16:19], v[216:219]
    v_mfma_f32_16x16x32_bf16 v[188:191], v[40:43], v[20:23], v[188:191]
    v_mfma_f32_16x16x32_bf16 v[204:207], v[44:47], v[20:23], v[204:207]
    v_mfma_f32_16x16x32_bf16 v[220:223], v[48:51], v[20:23], v[220:223]
    v_mfma_f32_16x16x32_bf16 v[192:195], v[40:43], v[24:27], v[192:195]
    v_mfma_f32_16x16x32_bf16 v[208:211], v[44:47], v[24:27], v[208:211]
    v_mfma_f32_16x16x32_bf16 v[224:227], v[48:51], v[24:27], v[224:227]
    v_mfma_f32_16x16x32_bf16 v[196:199], v[40:43], v[28:31], v[196:199]
    v_mfma_f32_16x16x32_bf16 v[212:215], v[44:47], v[28:31], v[212:215]
    v_mfma_f32_16x16x32_bf16 v[228:231], v[48:51], v[28:31], v[228:231]
    buffer_load_dwordx4 v[96:99], v8, s[24:27], s57 offen offset:0 sc1
    buffer_load_dwordx4 v[100:103], v8, s[24:27], s57 offen offset:1024 sc1
    buffer_load_dwordx4 v[104:107], v8, s[24:27], s57 offen offset:2048 sc1
    buffer_load_dwordx4 v[108:111], v8, s[24:27], s57 offen offset:3072 sc1
    buffer_load_dwordx4 v[112:115], v9, s[24:27], s57 offen offset:0 sc1
    s_add_u32 s57, s57, 5120
    s_cmp_eq_u32 s57, s58
    s_cselect_b32 s57, s56, s57
    buffer_load_dwordx4 v[116:119], v8, s[24:27], s57 offen offset:0 sc1
    buffer_load_dwordx4 v[120:123], v8, s[24:27], s57 offen offset:1024 sc1
    buffer_load_dwordx4 v[124:127], v8, s[24:27], s57 offen offset:2048 sc1
    buffer_load_dwordx4 v[128:131], v8, s[24:27], s57 offen offset:3072 sc1
    buffer_load_dwordx4 v[132:135], v9, s[24:27], s57 offen offset:0 sc1
    s_add_u32 s57, s57, 5120
    s_cmp_eq_u32 s57, s58
    s_cselect_b32 s57, s56, s57
    buffer_load_dwordx4 v[136:139], v8, s[24:27], s57 offen offset:0 sc1
    buffer_load_dwordx4 v[140:143], v8, s[24:27], s57 offen offset:1024 sc1
    buffer_load_dwordx4 v[144:147], v8, s[24:27], s57 offen offset:2048 sc1
    buffer_load_dwordx4 v[148:151], v8, s[24:27], s57 offen offset:3072 sc1
    buffer_load_dwordx4 v[232:235], v9, s[24:27], s57 offen offset:0 sc1
    s_add_u32 s57, s57, 5120
    s_cmp_eq_u32 s57, s58
    s_cselect_b32 s57, s56, s57
    s_mul_i32 s43, s39, 20480
    s_add_u32 s43, s43, 81920
    v_pk_mul_f32 v[152:153], v[184:185], v[184:185]
    v_pk_mul_f32 v[154:155], v[186:187], v[186:187]
    v_pk_mul_f32 v[156:157], v[200:201], v[200:201]
    v_pk_mul_f32 v[158:159], v[202:203], v[202:203]
    v_pk_fma_f32 v[152:153], v[152:153], v[32:33], v[32:33] op_sel:[0,0,1] op_sel_hi:[1,0,1]
    v_pk_fma_f32 v[154:155], v[154:155], v[32:33], v[32:33] op_sel:[0,0,1] op_sel_hi:[1,0,1]
    v_pk_fma_f32 v[156:157], v[156:157], v[32:33], v[32:33] op_sel:[0,0,1] op_sel_hi:[1,0,1]
    v_pk_fma_f32 v[158:159], v[158:159], v[32:33], v[32:33] op_sel:[0,0,1] op_sel_hi:[1,0,1]
    v_pk_mul_f32 v[152:153], v[152:153], v[184:185]
    v_pk_mul_f32 v[154:155], v[154:155], v[186:187]
    v_pk_mul_f32 v[156:157], v[156:157], v[200:201]
    v_pk_mul_f32 v[158:159], v[158:159], v[202:203]
    v_exp_f32 v152, v152
    v_exp_f32 v153, v153
    v_exp_f32 v154, v154
    v_exp_f32 v155, v155
    v_exp_f32 v156, v156
    v_exp_f32 v157, v157
    v_exp_f32 v158, v158
    v_exp_f32 v159, v159
    v_pk_fma_f32 v[152:153], v[152:153], v[248:249], v[248:249] op_sel_hi:[1,0,0]
    v_pk_fma_f32 v[154:155], v[154:155], v[248:249], v[248:249] op_sel_hi:[1,0,0]
    v_pk_fma_f32 v[156:157], v[156:157], v[248:249], v[248:249] op_sel_hi:[1,0,0]
    v_pk_fma_f32 v[158:159], v[158:159], v[248:249], v[248:249] op_sel_hi:[1,0,0]
    v_rcp_f32 v152, v152
    v_rcp_f32 v153, v153
    v_rcp_f32 v154, v154
    v_rcp_f32 v155, v155
    v_rcp_f32 v156, v156
    v_rcp_f32 v157, v157
    v_rcp_f32 v158, v158
    v_rcp_f32 v159, v159
    v_pk_mul_f32 v[152:153], v[152:153], v[184:185]
    v_pk_mul_f32 v[154:155], v[154:155], v[186:187]
    v_pk_mul_f32 v[156:157], v[156:157], v[200:201]
    v_pk_mul_f32 v[158:159], v[158:159], v[202:203]
    v_cvt_pk_bf16_f32 v160, v152, v153
    v_cvt_pk_bf16_f32 v161, v154, v155
    v_cvt_pk_bf16_f32 v162, v156, v157
    v_cvt_pk_bf16_f32 v163, v158, v159
    buffer_store_dwordx4 v[160:163], v8, s[20:23], s54 offen sc1
    s_add_u32 s54, s54, 49152
    v_pk_mul_f32 v[152:153], v[188:189], v[188:189]
    v_pk_mul_f32 v[154:155], v[190:191], v[190:191]
    v_pk_mul_f32 v[156:157], v[204:205], v[204:205]
    v_pk_mul_f32 v[158:159], v[206:207], v[206:207]
    v_pk_fma_f32 v[152:153], v[152:153], v[34:35], v[34:35] op_sel:[0,0,1] op_sel_hi:[1,0,1]
    v_pk_fma_f32 v[154:155], v[154:155], v[34:35], v[34:35] op_sel:[0,0,1] op_sel_hi:[1,0,1]
    v_pk_fma_f32 v[156:157], v[156:157], v[34:35], v[34:35] op_sel:[0,0,1] op_sel_hi:[1,0,1]
    v_pk_fma_f32 v[158:159], v[158:159], v[34:35], v[34:35] op_sel:[0,0,1] op_sel_hi:[1,0,1]
    v_pk_mul_f32 v[152:153], v[152:153], v[188:189]
    v_pk_mul_f32 v[154:155], v[154:155], v[190:191]
    v_pk_mul_f32 v[156:157], v[156:157], v[204:205]
    v_pk_mul_f32 v[158:159], v[158:159], v[206:207]
    v_exp_f32 v152, v152
    v_exp_f32 v153, v153
    v_exp_f32 v154, v154
    v_exp_f32 v155, v155
    v_exp_f32 v156, v156
    v_exp_f32 v157, v157
    v_exp_f32 v158, v158
    v_exp_f32 v159, v159
    v_pk_fma_f32 v[152:153], v[152:153], v[250:251], v[250:251] op_sel_hi:[1,0,0]
    v_pk_fma_f32 v[154:155], v[154:155], v[250:251], v[250:251] op_sel_hi:[1,0,0]
    v_pk_fma_f32 v[156:157], v[156:157], v[250:251], v[250:251] op_sel_hi:[1,0,0]
    v_pk_fma_f32 v[158:159], v[158:159], v[250:251], v[250:251] op_sel_hi:[1,0,0]
    v_rcp_f32 v152, v152
    v_rcp_f32 v153, v153
    v_rcp_f32 v154, v154
    v_rcp_f32 v155, v155
    v_rcp_f32 v156, v156
    v_rcp_f32 v157, v157
    v_rcp_f32 v158, v158
    v_rcp_f32 v159, v159
    v_pk_mul_f32 v[152:153], v[152:153], v[188:189]
    v_pk_mul_f32 v[154:155], v[154:155], v[190:191]
    v_pk_mul_f32 v[156:157], v[156:157], v[204:205]
    v_pk_mul_f32 v[158:159], v[158:159], v[206:207]
    v_cvt_pk_bf16_f32 v164, v152, v153
    v_cvt_pk_bf16_f32 v165, v154, v155
    v_cvt_pk_bf16_f32 v166, v156, v157
    v_cvt_pk_bf16_f32 v167, v158, v159
    buffer_store_dwordx4 v[164:167], v8, s[20:23], s54 offen sc1
    s_add_u32 s54, s54, 49152
    v_pk_mul_f32 v[152:153], v[192:193], v[192:193]
    v_pk_mul_f32 v[154:155], v[194:195], v[194:195]
    v_pk_mul_f32 v[156:157], v[208:209], v[208:209]
    v_pk_mul_f32 v[158:159], v[210:211], v[210:211]
    v_pk_fma_f32 v[152:153], v[152:153], v[36:37], v[36:37] op_sel:[0,0,1] op_sel_hi:[1,0,1]
    v_pk_fma_f32 v[154:155], v[154:155], v[36:37], v[36:37] op_sel:[0,0,1] op_sel_hi:[1,0,1]
    v_pk_fma_f32 v[156:157], v[156:157], v[36:37], v[36:37] op_sel:[0,0,1] op_sel_hi:[1,0,1]
    v_pk_fma_f32 v[158:159], v[158:159], v[36:37], v[36:37] op_sel:[0,0,1] op_sel_hi:[1,0,1]
    v_pk_mul_f32 v[152:153], v[152:153], v[192:193]
    v_pk_mul_f32 v[154:155], v[154:155], v[194:195]
    v_pk_mul_f32 v[156:157], v[156:157], v[208:209]
    v_pk_mul_f32 v[158:159], v[158:159], v[210:211]
    v_exp_f32 v152, v152
    v_exp_f32 v153, v153
    v_exp_f32 v154, v154
    v_exp_f32 v155, v155
    v_exp_f32 v156, v156
    v_exp_f32 v157, v157
    v_exp_f32 v158, v158
    v_exp_f32 v159, v159
    v_pk_fma_f32 v[152:153], v[152:153], v[252:253], v[252:253] op_sel_hi:[1,0,0]
    v_pk_fma_f32 v[154:155], v[154:155], v[252:253], v[252:253] op_sel_hi:[1,0,0]
    v_pk_fma_f32 v[156:157], v[156:157], v[252:253], v[252:253] op_sel_hi:[1,0,0]
    v_pk_fma_f32 v[158:159], v[158:159], v[252:253], v[252:253] op_sel_hi:[1,0,0]
    v_rcp_f32 v152, v152
    v_rcp_f32 v153, v153
    v_rcp_f32 v154, v154
    v_rcp_f32 v155, v155
    v_rcp_f32 v156, v156
    v_rcp_f32 v157, v157
    v_rcp_f32 v158, v158
    v_rcp_f32 v159, v159
    v_pk_mul_f32 v[152:153], v[152:153], v[192:193]
    v_pk_mul_f32 v[154:155], v[154:155], v[194:195]
    v_pk_mul_f32 v[156:157], v[156:157], v[208:209]
    v_pk_mul_f32 v[158:159], v[158:159], v[210:211]
    v_cvt_pk_bf16_f32 v168, v152, v153
    v_cvt_pk_bf16_f32 v169, v154, v155
    v_cvt_pk_bf16_f32 v170, v156, v157
    v_cvt_pk_bf16_f32 v171, v158, v159
    buffer_store_dwordx4 v[168:171], v8, s[20:23], s54 offen sc1
    s_add_u32 s54, s54, 49152
    v_pk_mul_f32 v[152:153], v[196:197], v[196:197]
    v_pk_mul_f32 v[154:155], v[198:199], v[198:199]
    v_pk_mul_f32 v[156:157], v[212:213], v[212:213]
    v_pk_mul_f32 v[158:159], v[214:215], v[214:215]
    v_pk_fma_f32 v[152:153], v[152:153], v[38:39], v[38:39] op_sel:[0,0,1] op_sel_hi:[1,0,1]
    v_pk_fma_f32 v[154:155], v[154:155], v[38:39], v[38:39] op_sel:[0,0,1] op_sel_hi:[1,0,1]
    v_pk_fma_f32 v[156:157], v[156:157], v[38:39], v[38:39] op_sel:[0,0,1] op_sel_hi:[1,0,1]
    v_pk_fma_f32 v[158:159], v[158:159], v[38:39], v[38:39] op_sel:[0,0,1] op_sel_hi:[1,0,1]
    v_pk_mul_f32 v[152:153], v[152:153], v[196:197]
    v_pk_mul_f32 v[154:155], v[154:155], v[198:199]
    v_pk_mul_f32 v[156:157], v[156:157], v[212:213]
    v_pk_mul_f32 v[158:159], v[158:159], v[214:215]
    v_exp_f32 v152, v152
    v_exp_f32 v153, v153
    v_exp_f32 v154, v154
    v_exp_f32 v155, v155
    v_exp_f32 v156, v156
    v_exp_f32 v157, v157
    v_exp_f32 v158, v158
    v_exp_f32 v159, v159
    v_pk_fma_f32 v[152:153], v[152:153], v[254:255], v[254:255] op_sel_hi:[1,0,0]
    v_pk_fma_f32 v[154:155], v[154:155], v[254:255], v[254:255] op_sel_hi:[1,0,0]
    v_pk_fma_f32 v[156:157], v[156:157], v[254:255], v[254:255] op_sel_hi:[1,0,0]
    v_pk_fma_f32 v[158:159], v[158:159], v[254:255], v[254:255] op_sel_hi:[1,0,0]
    v_rcp_f32 v152, v152
    v_rcp_f32 v153, v153
    v_rcp_f32 v154, v154
    v_rcp_f32 v155, v155
    v_rcp_f32 v156, v156
    v_rcp_f32 v157, v157
    v_rcp_f32 v158, v158
    v_rcp_f32 v159, v159
    v_pk_mul_f32 v[152:153], v[152:153], v[196:197]
    v_pk_mul_f32 v[154:155], v[154:155], v[198:199]
    v_pk_mul_f32 v[156:157], v[156:157], v[212:213]
    v_pk_mul_f32 v[158:159], v[158:159], v[214:215]
    v_cvt_pk_bf16_f32 v172, v152, v153
    v_cvt_pk_bf16_f32 v173, v154, v155
    v_cvt_pk_bf16_f32 v174, v156, v157
    v_cvt_pk_bf16_f32 v175, v158, v159
    buffer_store_dwordx4 v[172:175], v8, s[20:23], s54 offen sc1
    s_add_u32 s54, s54, 49152
    v_pk_mul_f32 v[152:153], v[216:217], v[216:217]
    v_pk_mul_f32 v[154:155], v[218:219], v[218:219]
    v_pk_mul_f32 v[156:157], v[220:221], v[220:221]
    v_pk_mul_f32 v[158:159], v[222:223], v[222:223]
    v_pk_fma_f32 v[152:153], v[152:153], v[32:33], v[32:33] op_sel:[0,0,1] op_sel_hi:[1,0,1]
    v_pk_fma_f32 v[154:155], v[154:155], v[32:33], v[32:33] op_sel:[0,0,1] op_sel_hi:[1,0,1]
    v_pk_fma_f32 v[156:157], v[156:157], v[34:35], v[34:35] op_sel:[0,0,1] op_sel_hi:[1,0,1]
    v_pk_fma_f32 v[158:159], v[158:159], v[34:35], v[34:35] op_sel:[0,0,1] op_sel_hi:[1,0,1]
    v_pk_mul_f32 v[152:153], v[152:153], v[216:217]
    v_pk_mul_f32 v[154:155], v[154:155], v[218:219]
    v_pk_mul_f32 v[156:157], v[156:157], v[220:221]
    v_pk_mul_f32 v[158:159], v[158:159], v[222:223]
    v_exp_f32 v152, v152
    v_exp_f32 v153, v153
    v_exp_f32 v154, v154
    v_exp_f32 v155, v155
    v_exp_f32 v156, v156
    v_exp_f32 v157, v157
    v_exp_f32 v158, v158
    v_exp_f32 v159, v159
    v_pk_fma_f32 v[152:153], v[152:153], v[248:249], v[248:249] op_sel_hi:[1,0,0]
    v_pk_fma_f32 v[154:155], v[154:155], v[248:249], v[248:249] op_sel_hi:[1,0,0]
    v_pk_fma_f32 v[156:157], v[156:157], v[250:251], v[250:251] op_sel_hi:[1,0,0]
    v_pk_fma_f32 v[158:159], v[158:159], v[250:251], v[250:251] op_sel_hi:[1,0,0]
    v_rcp_f32 v152, v152
    v_rcp_f32 v153, v153
    v_rcp_f32 v154, v154
    v_rcp_f32 v155, v155
    v_rcp_f32 v156, v156
    v_rcp_f32 v157, v157
    v_rcp_f32 v158, v158
    v_rcp_f32 v159, v159
    v_pk_mul_f32 v[152:153], v[152:153], v[216:217]
    v_pk_mul_f32 v[154:155], v[154:155], v[218:219]
    v_pk_mul_f32 v[156:157], v[156:157], v[220:221]
    v_pk_mul_f32 v[158:159], v[158:159], v[222:223]
    v_cvt_pk_bf16_f32 v176, v152, v153
    v_cvt_pk_bf16_f32 v177, v154, v155
    v_cvt_pk_bf16_f32 v178, v156, v157
    v_cvt_pk_bf16_f32 v179, v158, v159
    s_nop 1
    v_permlane16_swap_b32 v176, v178
    v_permlane16_swap_b32 v177, v179
    buffer_store_dwordx4 v[176:179], v4, s[20:23], s52 offen sc1
    s_add_u32 s52, s52, 98304
    v_pk_mul_f32 v[152:153], v[224:225], v[224:225]
    v_pk_mul_f32 v[154:155], v[226:227], v[226:227]
    v_pk_mul_f32 v[156:157], v[228:229], v[228:229]
    v_pk_mul_f32 v[158:159], v[230:231], v[230:231]
    v_pk_fma_f32 v[152:153], v[152:153], v[36:37], v[36:37] op_sel:[0,0,1] op_sel_hi:[1,0,1]
    v_pk_fma_f32 v[154:155], v[154:155], v[36:37], v[36:37] op_sel:[0,0,1] op_sel_hi:[1,0,1]
    v_pk_fma_f32 v[156:157], v[156:157], v[38:39], v[38:39] op_sel:[0,0,1] op_sel_hi:[1,0,1]
    v_pk_fma_f32 v[158:159], v[158:159], v[38:39], v[38:39] op_sel:[0,0,1] op_sel_hi:[1,0,1]
    v_pk_mul_f32 v[152:153], v[152:153], v[224:225]
    v_pk_mul_f32 v[154:155], v[154:155], v[226:227]
    v_pk_mul_f32 v[156:157], v[156:157], v[228:229]
    v_pk_mul_f32 v[158:159], v[158:159], v[230:231]
    v_exp_f32 v152, v152
    v_exp_f32 v153, v153
    v_exp_f32 v154, v154
    v_exp_f32 v155, v155
    v_exp_f32 v156, v156
    v_exp_f32 v157, v157
    v_exp_f32 v158, v158
    v_exp_f32 v159, v159
    v_pk_fma_f32 v[152:153], v[152:153], v[252:253], v[252:253] op_sel_hi:[1,0,0]
    v_pk_fma_f32 v[154:155], v[154:155], v[252:253], v[252:253] op_sel_hi:[1,0,0]
    v_pk_fma_f32 v[156:157], v[156:157], v[254:255], v[254:255] op_sel_hi:[1,0,0]
    v_pk_fma_f32 v[158:159], v[158:159], v[254:255], v[254:255] op_sel_hi:[1,0,0]
    v_rcp_f32 v152, v152
    v_rcp_f32 v153, v153
    v_rcp_f32 v154, v154
    v_rcp_f32 v155, v155
    v_rcp_f32 v156, v156
    v_rcp_f32 v157, v157
    v_rcp_f32 v158, v158
    v_rcp_f32 v159, v159
    v_pk_mul_f32 v[152:153], v[152:153], v[224:225]
    v_pk_mul_f32 v[154:155], v[154:155], v[226:227]
    v_pk_mul_f32 v[156:157], v[156:157], v[228:229]
    v_pk_mul_f32 v[158:159], v[158:159], v[230:231]
    v_cvt_pk_bf16_f32 v180, v152, v153
    v_cvt_pk_bf16_f32 v181, v154, v155
    v_cvt_pk_bf16_f32 v182, v156, v157
    v_cvt_pk_bf16_f32 v183, v158, v159
    s_nop 1
    v_permlane16_swap_b32 v180, v182
    v_permlane16_swap_b32 v181, v183
    buffer_store_dwordx4 v[180:183], v4, s[20:23], s52 offen sc1
    s_add_u32 s52, s52, 98304
    s_mov_b64 exec, 1
    ds_add_u32 v11, v13 offset:32
    s_mov_b64 exec, -1
    s_lshr_b32 s52, s34, 1
    s_lshl_b32 s52, s52, 7
    s_and_b32 s53, s34, 1
    s_lshl_b32 s53, s53, 2
    s_add_u32 s53, s53, s39
    s_lshl_b32 s53, s53, 2
    s_add_u32 s52, s52, s53
    s_lshl_b32 s54, s33, 12
    s_add_u32 s52, s52, s54
    v_lshlrev_b32 v3, 9, v1
    s_lshl_b32 s53, s34, 2
    s_add_u32 s53, s53, s39
    s_mul_i32 s55, s53, 80
    s_lshl_b32 s53, s53, 7
    s_add_u32 s53, s53, s54
    s_add_u32 s35, s39, 0
    s_and_b32 s35, s35, 3
    s_mul_i32 s35, s35, 49152
    v_add_u32 v4, s35, v8
    s_add_u32 s35, s39, 1
    s_and_b32 s35, s35, 3
    s_mul_i32 s35, s35, 49152
    v_add_u32 v5, s35, v8
    s_add_u32 s35, s39, 2
    s_and_b32 s35, s35, 3
    s_mul_i32 s35, s35, 49152
    v_add_u32 v6, s35, v8
    s_add_u32 s35, s39, 3
    s_and_b32 s35, s35, 3
    s_mul_i32 s35, s35, 49152
    v_add_u32 v7, s35, v8
L_cw_12:
    ds_read_b32 v2, v15 offset:8
    s_add_u32 s41, s41, 1
    s_cmp_gt_u32 s41, 400000
    s_waitcnt lgkmcnt(0)
    s_cbranch_scc1 L_cwd_13
    v_readfirstlane_b32 s64, v2
    s_cmp_ge_u32 s64, 5
    s_cbranch_scc1 L_cwd_13
    s_branch L_cw_12
L_cwd_13:
    s_mov_b32 s41, 0
    s_waitcnt vmcnt(0)
    s_mov_b64 exec, 0xff
    buffer_store_dword v14, v3, s[28:31], s52 offen sc1
    s_mov_b64 exec, -1
    s_add_u32 m0, s43, 0
    s_nop 0
    buffer_load_dwordx4 v8, s[24:27], s57 offen offset:0 sc1 lds
    buffer_load_dwordx4 v8, s[24:27], s57 offen offset:1024 sc1 lds
    buffer_load_dwordx4 v8, s[24:27], s57 offen offset:2048 sc1 lds
    buffer_load_dwordx4 v8, s[24:27], s57 offen offset:3072 sc1 lds
    s_add_u32 m0, s43, 4096
    s_nop 0
    buffer_load_dwordx4 v9, s[24:27], s57 offen sc1 lds
    s_add_u32 s57, s57, 5120
    s_cmp_eq_u32 s57, s58
    s_cselect_b32 s57, s56, s57
    s_add_u32 m0, s43, 5120
    s_nop 0
    buffer_load_dwordx4 v8, s[24:27], s57 offen offset:0 sc1 lds
    buffer_load_dwordx4 v8, s[24:27], s57 offen offset:1024 sc1 lds
    buffer_load_dwordx4 v8, s[24:27], s57 offen offset:2048 sc1 lds
    buffer_load_dwordx4 v8, s[24:27], s57 offen offset:3072 sc1 lds
    s_add_u32 m0, s43, 9216
    s_nop 0
    buffer_load_dwordx4 v9, s[24:27], s57 offen sc1 lds
    s_add_u32 s57, s57, 5120
    s_cmp_eq_u32 s57, s58
    s_cselect_b32 s57, s56, s57
    s_add_u32 m0, s43, 10240
    s_nop 0
    buffer_load_dwordx4 v8, s[24:27], s57 offen offset:0 sc1 lds
    buffer_load_dwordx4 v8, s[24:27], s57 offen offset:1024 sc1 lds
    buffer_load_dwordx4 v8, s[24:27], s57 offen offset:2048 sc1 lds
    buffer_load_dwordx4 v8, s[24:27], s57 offen offset:3072 sc1 lds
    s_add_u32 m0, s43, 14336
    s_nop 0
    buffer_load_dwordx4 v9, s[24:27], s57 offen sc1 lds
    s_add_u32 s57, s57, 5120
    s_cmp_eq_u32 s57, s58
    s_cselect_b32 s57, s56, s57
    s_add_u32 m0, s43, 15360
    s_nop 0
    buffer_load_dwordx4 v8, s[24:27], s57 offen offset:0 sc1 lds
    buffer_load_dwordx4 v8, s[24:27], s57 offen offset:1024 sc1 lds
    buffer_load_dwordx4 v8, s[24:27], s57 offen offset:2048 sc1 lds
    buffer_load_dwordx4 v8, s[24:27], s57 offen offset:3072 sc1 lds
    s_add_u32 m0, s43, 19456
    s_nop 0
    buffer_load_dwordx4 v9, s[24:27], s57 offen sc1 lds
    s_add_u32 s57, s57, 5120
    s_cmp_eq_u32 s57, s58
    s_cselect_b32 s57, s56, s57
    s_mov_b32 s12, s90
    s_mov_b32 s13, s91
    s_mov_b32 s14, 0x500
    s_mov_b32 s15, 0x20000
    s_mov_b32 s16, s92
    s_mov_b32 s17, s93
    s_mov_b32 s18, 0x280000
    s_mov_b32 s19, 0x20000
    v_and_b32 v15, 15, v1
    v_mul_u32_u24 v15, 160, v15
    v_mul_u32_u24 v13, 40, v12
    v_add3_u32 v15, v15, v13, s43
    v_add_u32 v2, 0, v1
    v_mul_u32_u24 v3, 205, v2
    v_lshrrev_b32 v3, 11, v3
    v_mul_u32_u24 v3, 1120, v3
    v_lshl_add_u32 v250, v2, 4, v3
    v_add_u32 v2, 64, v1
    v_mul_u32_u24 v3, 205, v2
    v_lshrrev_b32 v3, 11, v3
    v_mul_u32_u24 v3, 1120, v3
    v_lshl_add_u32 v252, v2, 4, v3
    v_add_u32 v2, 128, v1
    v_mul_u32_u24 v3, 205, v2
    v_lshrrev_b32 v3, 11, v3
    v_mul_u32_u24 v3, 1120, v3
    v_lshl_add_u32 v253, v2, 4, v3
    s_mul_i32 s51, s34, 160
    s_add_u32 s50, s42, s51
    v_and_b32 v248, 3, v1
    v_mov_b32 v10, 31232
    v_mov_b32 v11, 1
    v_add_u32 v251, s43, v8
    v_bfe_u32 v2, v1, 2, 2
    v_mul_u32_u24 v2, 144, v2
    v_lshl_add_u32 v2, v248, 3, v2
    v_mul_u32_u24 v3, 2880, v12
    s_lshl_b32 s35, s39, 5
    s_add_u32 s35, s35, 69632
    v_add3_u32 v2, v2, v3, s35
    v_lshrrev_b32 v3, 1, v12
    v_mul_u32_u24 v3, 6528, v3
    v_add_u32 v249, v2, v3
    v_subrev_u32 v249, 32256, v249
    s_mov_b32 s48, 0xbfb8aa3b
L_poll_14:
    s_buffer_load_dwordx8 s[64:71], s[28:31], s53 offset:0 glc
L_poll_14_g:
    s_add_u32 s41, s41, 1
    s_cmp_gt_u32 s41, 50000
    s_waitcnt lgkmcnt(0)
    s_cbranch_scc1 L_polld_15
    s_xor_b64 s[64:65], s[64:65], s[80:81]
    s_xor_b64 s[66:67], s[66:67], s[80:81]
    s_xor_b64 s[68:69], s[68:69], s[80:81]
    s_xor_b64 s[70:71], s[70:71], s[80:81]
    s_or_b64 s[64:65], s[64:65], s[66:67]
    s_or_b64 s[64:65], s[64:65], s[68:69]
    s_or_b64 s[64:65], s[64:65], s[70:71]
    s_cbranch_scc1 L_poll_14
L_polld_15:
    buffer_load_dwordx4 v[236:239], v4, s[20:23], s60 offen sc1
    buffer_load_dwordx4 v[240:243], v5, s[20:23], s60 offen sc1
    buffer_load_dwordx4 v[244:247], v6, s[20:23], s60 offen sc1
    buffer_load_dwordx4 v[16:19], v7, s[20:23], s60 offen sc1
    s_add_u32 s60, s60, 1024
    s_cmp_eq_u32 s60, s61
    s_cselect_b32 s60, s59, s60
    buffer_load_dwordx4 v[20:23], v4, s[20:23], s60 offen sc1
    buffer_load_dwordx4 v[24:27], v5, s[20:23], s60 offen sc1
    buffer_load_dwordx4 v[28:31], v6, s[20:23], s60 offen sc1
    buffer_load_dwordx4 v[32:35], v7, s[20:23], s60 offen sc1
    s_add_u32 s60, s60, 1024
    s_cmp_eq_u32 s60, s61
    s_cselect_b32 s60, s59, s60
    buffer_load_dwordx4 v[36:39], v4, s[20:23], s60 offen sc1
    buffer_load_dwordx4 v[40:43], v5, s[20:23], s60 offen sc1
    buffer_load_dwordx4 v[44:47], v6, s[20:23], s60 offen sc1
    buffer_load_dwordx4 v[48:51], v7, s[20:23], s60 offen sc1
    s_add_u32 s60, s60, 1024
    s_cmp_eq_u32 s60, s61
    s_cselect_b32 s60, s59, s60
    s_waitcnt vmcnt(11)
    v_mfma_f32_16x16x32_bf16 v[152:155], v[56:59], v[236:239], 0
    v_mfma_f32_16x16x32_bf16 v[156:159], v[60:63], v[236:239], 0
    v_mfma_f32_16x16x32_bf16 v[160:163], v[64:67], v[236:239], 0
    v_mfma_f32_16x16x32_bf16 v[164:167], v[68:71], v[236:239], 0
    v_mfma_f32_16x16x32_bf16 v[168:171], v[72:75], v[236:239], 0
    s_waitcnt vmcnt(10)
    v_mfma_f32_16x16x32_bf16 v[172:175], v[56:59], v[240:243], 0
    v_mfma_f32_16x16x32_bf16 v[176:179], v[60:63], v[240:243], 0
    v_mfma_f32_16x16x32_bf16 v[180:183], v[64:67], v[240:243], 0
    v_mfma_f32_16x16x32_bf16 v[184:187], v[68:71], v[240:243], 0
    v_mfma_f32_16x16x32_bf16 v[188:191], v[72:75], v[240:243], 0
    s_waitcnt vmcnt(9)
    v_mfma_f32_16x16x32_bf16 v[192:195], v[56:59], v[244:247], 0
    v_mfma_f32_16x16x32_bf16 v[196:199], v[60:63], v[244:247], 0
    v_mfma_f32_16x16x32_bf16 v[200:203], v[64:67], v[244:247], 0
    v_mfma_f32_16x16x32_bf16 v[204:207], v[68:71], v[244:247], 0
    v_mfma_f32_16x16x32_bf16 v[208:211], v[72:75], v[244:247], 0
    s_waitcnt vmcnt(8)
    v_mfma_f32_16x16x32_bf16 v[212:215], v[56:59], v[16:19], 0
    v_mfma_f32_16x16x32_bf16 v[216:219], v[60:63], v[16:19], 0
    v_mfma_f32_16x16x32_bf16 v[220:223], v[64:67], v[16:19], 0
    v_mfma_f32_16x16x32_bf16 v[224:227], v[68:71], v[16:19], 0
    v_mfma_f32_16x16x32_bf16 v[228:231], v[72:75], v[16:19], 0
    s_waitcnt vmcnt(7)
    v_mfma_f32_16x16x32_bf16 v[152:155], v[76:79], v[20:23], v[152:155]
    buffer_load_dwordx4 v[52:55], v4, s[20:23], s60 offen sc1
    v_mfma_f32_16x16x32_bf16 v[156:159], v[80:83], v[20:23], v[156:159]
    v_mfma_f32_16x16x32_bf16 v[160:163], v[84:87], v[20:23], v[160:163]
    buffer_load_dwordx4 v[56:59], v5, s[20:23], s60 offen sc1
    v_mfma_f32_16x16x32_bf16 v[164:167], v[88:91], v[20:23], v[164:167]
    v_mfma_f32_16x16x32_bf16 v[168:171], v[92:95], v[20:23], v[168:171]
    buffer_load_dwordx4 v[60:63], v6, s[20:23], s60 offen sc1
    s_waitcnt vmcnt(9)
    v_mfma_f32_16x16x32_bf16 v[172:175], v[76:79], v[24:27], v[172:175]
    v_mfma_f32_16x16x32_bf16 v[176:179], v[80:83], v[24:27], v[176:179]
    buffer_load_dwordx4 v[64:67], v7, s[20:23], s60 offen sc1
    s_add_u32 s60, s60, 1024
    s_cmp_eq_u32 s60, s61
    s_cselect_b32 s60, s59, s60
    v_mfma_f32_16x16x32_bf16 v[180:183], v[84:87], v[24:27], v[180:183]
    v_mfma_f32_16x16x32_bf16 v[184:187], v[88:91], v[24:27], v[184:187]
    buffer_load_dwordx4 v[68:71], v4, s[20:23], s60 offen sc1
    v_mfma_f32_16x16x32_bf16 v[188:191], v[92:95], v[24:27], v[188:191]
    s_waitcnt vmcnt(10)
    v_mfma_f32_16x16x32_bf16 v[192:195], v[76:79], v[28:31], v[192:195]
    buffer_load_dwordx4 v[72:75], v5, s[20:23], s60 offen sc1
    v_mfma_f32_16x16x32_bf16 v[196:199], v[80:83], v[28:31], v[196:199]
    v_mfma_f32_16x16x32_bf16 v[200:203], v[84:87], v[28:31], v[200:203]
    buffer_load_dwordx4 v[236:239], v6, s[20:23], s60 offen sc1
    v_mfma_f32_16x16x32_bf16 v[204:207], v[88:91], v[28:31], v[204:207]
    v_mfma_f32_16x16x32_bf16 v[208:211], v[92:95], v[28:31], v[208:211]
    buffer_load_dwordx4 v[240:243], v7, s[20:23], s60 offen sc1
    s_add_u32 s60, s60, 1024
    s_cmp_eq_u32 s60, s61
    s_cselect_b32 s60, s59, s60
    s_waitcnt vmcnt(12)
    v_mfma_f32_16x16x32_bf16 v[212:215], v[76:79], v[32:35], v[212:215]
    v_mfma_f32_16x16x32_bf16 v[216:219], v[80:83], v[32:35], v[216:219]
    v_mfma_f32_16x16x32_bf16 v[220:223], v[84:87], v[32:35], v[220:223]
    v_mfma_f32_16x16x32_bf16 v[224:227], v[88:91], v[32:35], v[224:227]
    v_mfma_f32_16x16x32_bf16 v[228:231], v[92:95], v[32:35], v[228:231]
    s_waitcnt vmcnt(11)
    v_mfma_f32_16x16x32_bf16 v[152:155], v[96:99], v[36:39], v[152:155]
    buffer_load_dwordx4 v[244:247], v4, s[20:23], s60 offen sc1
    v_mfma_f32_16x16x32_bf16 v[156:159], v[100:103], v[36:39], v[156:159]
    v_mfma_f32_16x16x32_bf16 v[160:163], v[104:107], v[36:39], v[160:163]
    buffer_load_dwordx4 v[16:19], v5, s[20:23], s60 offen sc1
    v_mfma_f32_16x16x32_bf16 v[164:167], v[108:111], v[36:39], v[164:167]
    v_mfma_f32_16x16x32_bf16 v[168:171], v[112:115], v[36:39], v[168:171]
    buffer_load_dwordx4 v[76:79], v6, s[20:23], s60 offen sc1
    s_waitcnt vmcnt(13)
    v_mfma_f32_16x16x32_bf16 v[172:175], v[96:99], v[40:43], v[172:175]
    v_mfma_f32_16x16x32_bf16 v[176:179], v[100:103], v[40:43], v[176:179]
    buffer_load_dwordx4 v[80:83], v7, s[20:23], s60 offen sc1
    s_add_u32 s60, s60, 1024
    s_cmp_eq_u32 s60, s61
    s_cselect_b32 s60, s59, s60
    v_mfma_f32_16x16x32_bf16 v[180:183], v[104:107], v[40:43], v[180:183]
    v_mfma_f32_16x16x32_bf16 v[184:187], v[108:111], v[40:43], v[184:187]
    buffer_load_dwordx4 v[84:87], v4, s[20:23], s60 offen sc1
    v_mfma_f32_16x16x32_bf16 v[188:191], v[112:115], v[40:43], v[188:191]
    s_waitcnt vmcnt(14)
    v_mfma_f32_16x16x32_bf16 v[192:195], v[96:99], v[44:47], v[192:195]
    buffer_load_dwordx4 v[88:91], v5, s[20:23], s60 offen sc1
    v_mfma_f32_16x16x32_bf16 v[196:199], v[100:103], v[44:47], v[196:199]
    v_mfma_f32_16x16x32_bf16 v[200:203], v[104:107], v[44:47], v[200:203]
    buffer_load_dwordx4 v[92:95], v6, s[20:23], s60 offen sc1
    v_mfma_f32_16x16x32_bf16 v[204:207], v[108:111], v[44:47], v[204:207]
    v_mfma_f32_16x16x32_bf16 v[208:211], v[112:115], v[44:47], v[208:211]
    buffer_load_dwordx4 v[20:23], v7, s[20:23], s60 offen sc1
    s_add_u32 s60, s60, 1024
    s_cmp_eq_u32 s60, s61
    s_cselect_b32 s60, s59, s60
    s_waitcnt vmcnt(16)
    v_mfma_f32_16x16x32_bf16 v[212:215], v[96:99], v[48:51], v[212:215]
    v_mfma_f32_16x16x32_bf16 v[216:219], v[100:103], v[48:51], v[216:219]
    v_mfma_f32_16x16x32_bf16 v[220:223], v[104:107], v[48:51], v[220:223]
    v_mfma_f32_16x16x32_bf16 v[224:227], v[108:111], v[48:51], v[224:227]
    v_mfma_f32_16x16x32_bf16 v[228:231], v[112:115], v[48:51], v[228:231]
    s_waitcnt vmcnt(15)
    v_mfma_f32_16x16x32_bf16 v[152:155], v[116:119], v[52:55], v[152:155]
    buffer_load_dwordx4 v[24:27], v4, s[20:23], s60 offen sc1
    v_mfma_f32_16x16x32_bf16 v[156:159], v[120:123], v[52:55], v[156:159]
    v_mfma_f32_16x16x32_bf16 v[160:163], v[124:127], v[52:55], v[160:163]
    buffer_load_dwordx4 v[28:31], v5, s[20:23], s60 offen sc1
    v_mfma_f32_16x16x32_bf16 v[164:167], v[128:131], v[52:55], v[164:167]
    v_mfma_f32_16x16x32_bf16 v[168:171], v[132:135], v[52:55], v[168:171]
    buffer_load_dwordx4 v[32:35], v6, s[20:23], s60 offen sc1
    s_waitcnt vmcnt(17)
    v_mfma_f32_16x16x32_bf16 v[172:175], v[116:119], v[56:59], v[172:175]
    v_mfma_f32_16x16x32_bf16 v[176:179], v[120:123], v[56:59], v[176:179]
    buffer_load_dwordx4 v[96:99], v7, s[20:23], s60 offen sc1
    s_add_u32 s60, s60, 1024
    s_cmp_eq_u32 s60, s61
    s_cselect_b32 s60, s59, s60
    v_mfma_f32_16x16x32_bf16 v[180:183], v[124:127], v[56:59], v[180:183]
    v_mfma_f32_16x16x32_bf16 v[184:187], v[128:131], v[56:59], v[184:187]
    buffer_load_dwordx4 v[100:103], v4, s[20:23], s60 offen sc1
    v_mfma_f32_16x16x32_bf16 v[188:191], v[132:135], v[56:59], v[188:191]
    s_waitcnt vmcnt(18)
    v_mfma_f32_16x16x32_bf16 v[192:195], v[116:119], v[60:63], v[192:195]
    buffer_load_dwordx4 v[104:107], v5, s[20:23], s60 offen sc1
    v_mfma_f32_16x16x32_bf16 v[196:199], v[120:123], v[60:63], v[196:199]
    v_mfma_f32_16x16x32_bf16 v[200:203], v[124:127], v[60:63], v[200:203]
    buffer_load_dwordx4 v[108:111], v6, s[20:23], s60 offen sc1
    v_mfma_f32_16x16x32_bf16 v[204:207], v[128:131], v[60:63], v[204:207]
    v_mfma_f32_16x16x32_bf16 v[208:211], v[132:135], v[60:63], v[208:211]
    buffer_load_dwordx4 v[112:115], v7, s[20:23], s60 offen sc1
    s_add_u32 s60, s60, 1024
    s_cmp_eq_u32 s60, s61
    s_cselect_b32 s60, s59, s60
    s_waitcnt vmcnt(20)
    v_mfma_f32_16x16x32_bf16 v[212:215], v[116:119], v[64:67], v[212:215]
    v_mfma_f32_16x16x32_bf16 v[216:219], v[120:123], v[64:67], v[216:219]
    v_mfma_f32_16x16x32_bf16 v[220:223], v[124:127], v[64:67], v[220:223]
    v_mfma_f32_16x16x32_bf16 v[224:227], v[128:131], v[64:67], v[224:227]
    v_mfma_f32_16x16x32_bf16 v[228:231], v[132:135], v[64:67], v[228:231]
    s_waitcnt vmcnt(19)
    v_mfma_f32_16x16x32_bf16 v[152:155], v[136:139], v[68:71], v[152:155]
    v_mfma_f32_16x16x32_bf16 v[156:159], v[140:143], v[68:71], v[156:159]
    ds_read_b128 v[36:39], v251 offset:0
    v_mfma_f32_16x16x32_bf16 v[160:163], v[144:147], v[68:71], v[160:163]
    v_mfma_f32_16x16x32_bf16 v[164:167], v[148:151], v[68:71], v[164:167]
    ds_read_b128 v[40:43], v251 offset:1024
    v_mfma_f32_16x16x32_bf16 v[168:171], v[232:235], v[68:71], v[168:171]
    s_waitcnt vmcnt(18)
    v_mfma_f32_16x16x32_bf16 v[172:175], v[136:139], v[72:75], v[172:175]
    ds_read_b128 v[44:47], v251 offset:2048
    v_mfma_f32_16x16x32_bf16 v[176:179], v[140:143], v[72:75], v[176:179]
    v_mfma_f32_16x16x32_bf16 v[180:183], v[144:147], v[72:75], v[180:183]
    ds_read_b128 v[48:51], v251 offset:3072
    v_mfma_f32_16x16x32_bf16 v[184:187], v[148:151], v[72:75], v[184:187]
    v_mfma_f32_16x16x32_bf16 v[188:191], v[232:235], v[72:75], v[188:191]
    ds_read_b128 v[116:119], v251 offset:4096
    s_waitcnt vmcnt(17)
    v_mfma_f32_16x16x32_bf16 v[192:195], v[136:139], v[236:239], v[192:195]
    buffer_load_dwordx4 v[120:123], v8, s[24:27], s57 offen offset:0 sc1
    v_mfma_f32_16x16x32_bf16 v[196:199], v[140:143], v[236:239], v[196:199]
    v_mfma_f32_16x16x32_bf16 v[200:203], v[144:147], v[236:239], v[200:203]
    buffer_load_dwordx4 v[124:127], v8, s[24:27], s57 offen offset:1024 sc1
    v_mfma_f32_16x16x32_bf16 v[204:207], v[148:151], v[236:239], v[204:207]
    v_mfma_f32_16x16x32_bf16 v[208:211], v[232:235], v[236:239], v[208:211]
    buffer_load_dwordx4 v[128:131], v8, s[24:27], s57 offen offset:2048 sc1
    s_waitcnt vmcnt(19)
    v_mfma_f32_16x16x32_bf16 v[212:215], v[136:139], v[240:243], v[212:215]
    v_mfma_f32_16x16x32_bf16 v[216:219], v[140:143], v[240:243], v[216:219]
    buffer_load_dwordx4 v[132:135], v8, s[24:27], s57 offen offset:3072 sc1
    v_mfma_f32_16x16x32_bf16 v[220:223], v[144:147], v[240:243], v[220:223]
    v_mfma_f32_16x16x32_bf16 v[224:227], v[148:151], v[240:243], v[224:227]
    buffer_load_dwordx4 v[52:55], v9, s[24:27], s57 offen offset:0 sc1
    s_add_u32 s57, s57, 5120
    s_cmp_eq_u32 s57, s58
    s_cselect_b32 s57, s56, s57
    v_mfma_f32_16x16x32_bf16 v[228:231], v[232:235], v[240:243], v[228:231]
    s_waitcnt lgkmcnt(0)
    s_waitcnt vmcnt(20)
    v_mfma_f32_16x16x32_bf16 v[152:155], v[36:39], v[244:247], v[152:155]
    v_mfma_f32_16x16x32_bf16 v[156:159], v[40:43], v[244:247], v[156:159]
    v_mfma_f32_16x16x32_bf16 v[160:163], v[44:47], v[244:247], v[160:163]
    ds_read_b128 v[56:59], v251 offset:5120
    v_mfma_f32_16x16x32_bf16 v[164:167], v[48:51], v[244:247], v[164:167]
    v_mfma_f32_16x16x32_bf16 v[168:171], v[116:119], v[244:247], v[168:171]
    ds_read_b128 v[60:63], v251 offset:6144
    s_waitcnt vmcnt(19)
    v_mfma_f32_16x16x32_bf16 v[172:175], v[36:39], v[16:19], v[172:175]
    v_mfma_f32_16x16x32_bf16 v[176:179], v[40:43], v[16:19], v[176:179]
    ds_read_b128 v[64:67], v251 offset:7168
    v_mfma_f32_16x16x32_bf16 v[180:183], v[44:47], v[16:19], v[180:183]
    v_mfma_f32_16x16x32_bf16 v[184:187], v[48:51], v[16:19], v[184:187]
    ds_read_b128 v[136:139], v251 offset:8192
    v_mfma_f32_16x16x32_bf16 v[188:191], v[116:119], v[16:19], v[188:191]
    s_waitcnt vmcnt(18)
    v_mfma_f32_16x16x32_bf16 v[192:195], v[36:39], v[76:79], v[192:195]
    ds_read_b128 v[140:143], v251 offset:9216
    v_mfma_f32_16x16x32_bf16 v[196:199], v[40:43], v[76:79], v[196:199]
    v_mfma_f32_16x16x32_bf16 v[200:203], v[44:47], v[76:79], v[200:203]
    buffer_load_dwordx4 v[144:147], v4, s[20:23], s60 offen sc1
    v_mfma_f32_16x16x32_bf16 v[204:207], v[48:51], v[76:79], v[204:207]
    v_mfma_f32_16x16x32_bf16 v[208:211], v[116:119], v[76:79], v[208:211]
    buffer_load_dwordx4 v[148:151], v5, s[20:23], s60 offen sc1
    s_waitcnt vmcnt(19)
    v_mfma_f32_16x16x32_bf16 v[212:215], v[36:39], v[80:83], v[212:215]
    v_mfma_f32_16x16x32_bf16 v[216:219], v[40:43], v[80:83], v[216:219]
    buffer_load_dwordx4 v[232:235], v6, s[20:23], s60 offen sc1
    v_mfma_f32_16x16x32_bf16 v[220:223], v[44:47], v[80:83], v[220:223]
    v_mfma_f32_16x16x32_bf16 v[224:227], v[48:51], v[80:83], v[224:227]
    buffer_load_dwordx4 v[68:71], v7, s[20:23], s60 offen sc1
    s_add_u32 s60, s60, 1024
    s_cmp_eq_u32 s60, s61
    s_cselect_b32 s60, s59, s60
    v_mfma_f32_16x16x32_bf16 v[228:231], v[116:119], v[80:83], v[228:231]
    s_waitcnt lgkmcnt(0)
    s_waitcnt vmcnt(20)
    v_mfma_f32_16x16x32_bf16 v[152:155], v[56:59], v[84:87], v[152:155]
    v_mfma_f32_16x16x32_bf16 v[156:159], v[60:63], v[84:87], v[156:159]
    ds_read_b128 v[72:75], v251 offset:10240
    v_mfma_f32_16x16x32_bf16 v[160:163], v[64:67], v[84:87], v[160:163]
    v_mfma_f32_16x16x32_bf16 v[164:167], v[136:139], v[84:87], v[164:167]
    ds_read_b128 v[236:239], v251 offset:11264
    v_mfma_f32_16x16x32_bf16 v[168:171], v[140:143], v[84:87], v[168:171]
    s_waitcnt vmcnt(19)
    v_mfma_f32_16x16x32_bf16 v[172:175], v[56:59], v[88:91], v[172:175]
    ds_read_b128 v[240:243], v251 offset:12288
    v_mfma_f32_16x16x32_bf16 v[176:179], v[60:63], v[88:91], v[176:179]
    v_mfma_f32_16x16x32_bf16 v[180:183], v[64:67], v[88:91], v[180:183]
    ds_read_b128 v[36:39], v251 offset:13312
    v_mfma_f32_16x16x32_bf16 v[184:187], v[136:139], v[88:91], v[184:187]
    v_mfma_f32_16x16x32_bf16 v[188:191], v[140:143], v[88:91], v[188:191]
    ds_read_b128 v[40:43], v251 offset:14336
    s_waitcnt vmcnt(18)
    v_mfma_f32_16x16x32_bf16 v[192:195], v[56:59], v[92:95], v[192:195]
    buffer_load_dwordx4 v[44:47], v8, s[24:27], s57 offen offset:0 sc1
    v_mfma_f32_16x16x32_bf16 v[196:199], v[60:63], v[92:95], v[196:199]
    v_mfma_f32_16x16x32_bf16 v[200:203], v[64:67], v[92:95], v[200:203]
    buffer_load_dwordx4 v[48:51], v8, s[24:27], s57 offen offset:1024 sc1
    v_mfma_f32_16x16x32_bf16 v[204:207], v[136:139], v[92:95], v[204:207]
    v_mfma_f32_16x16x32_bf16 v[208:211], v[140:143], v[92:95], v[208:211]
    buffer_load_dwordx4 v[116:119], v8, s[24:27], s57 offen offset:2048 sc1
    s_waitcnt vmcnt(20)
    v_mfma_f32_16x16x32_bf16 v[212:215], v[56:59], v[20:23], v[212:215]
    v_mfma_f32_16x16x32_bf16 v[216:219], v[60:63], v[20:23], v[216:219]
    buffer_load_dwordx4 v[244:247], v8, s[24:27], s57 offen offset:3072 sc1
    v_mfma_f32_16x16x32_bf16 v[220:223], v[64:67], v[20:23], v[220:223]
    v_mfma_f32_16x16x32_bf16 v[224:227], v[136:139], v[20:23], v[224:227]
    buffer_load_dwordx4 v[16:19], v9, s[24:27], s57 offen offset:0 sc1
    s_add_u32 s57, s57, 5120
    s_cmp_eq_u32 s57, s58
    s_cselect_b32 s57, s56, s57
    v_mfma_f32_16x16x32_bf16 v[228:231], v[140:143], v[20:23], v[228:231]
    s_waitcnt lgkmcnt(0)
    s_waitcnt vmcnt(21)
    v_mfma_f32_16x16x32_bf16 v[152:155], v[72:75], v[24:27], v[152:155]
    v_mfma_f32_16x16x32_bf16 v[156:159], v[236:239], v[24:27], v[156:159]
    v_mfma_f32_16x16x32_bf16 v[160:163], v[240:243], v[24:27], v[160:163]
    ds_read_b128 v[76:79], v251 offset:15360
    v_mfma_f32_16x16x32_bf16 v[164:167], v[36:39], v[24:27], v[164:167]
    v_mfma_f32_16x16x32_bf16 v[168:171], v[40:43], v[24:27], v[168:171]
    ds_read_b128 v[80:83], v251 offset:16384
    s_waitcnt vmcnt(20)
    v_mfma_f32_16x16x32_bf16 v[172:175], v[72:75], v[28:31], v[172:175]
    v_mfma_f32_16x16x32_bf16 v[176:179], v[236:239], v[28:31], v[176:179]
    ds_read_b128 v[56:59], v251 offset:17408
    v_mfma_f32_16x16x32_bf16 v[180:183], v[240:243], v[28:31], v[180:183]
    v_mfma_f32_16x16x32_bf16 v[184:187], v[36:39], v[28:31], v[184:187]
    ds_read_b128 v[60:63], v251 offset:18432
    v_mfma_f32_16x16x32_bf16 v[188:191], v[40:43], v[28:31], v[188:191]
    s_waitcnt vmcnt(19)
    v_mfma_f32_16x16x32_bf16 v[192:195], v[72:75], v[32:35], v[192:195]
    ds_read_b128 v[64:67], v251 offset:19456
    v_mfma_f32_16x16x32_bf16 v[196:199], v[236:239], v[32:35], v[196:199]
    v_mfma_f32_16x16x32_bf16 v[200:203], v[240:243], v[32:35], v[200:203]
    buffer_load_dwordx4 v[136:139], v4, s[20:23], s60 offen sc1
    v_mfma_f32_16x16x32_bf16 v[204:207], v[36:39], v[32:35], v[204:207]
    v_mfma_f32_16x16x32_bf16 v[208:211], v[40:43], v[32:35], v[208:211]
    buffer_load_dwordx4 v[140:143], v5, s[20:23], s60 offen sc1
    s_waitcnt vmcnt(20)
    v_mfma_f32_16x16x32_bf16 v[212:215], v[72:75], v[96:99], v[212:215]
    v_mfma_f32_16x16x32_bf16 v[216:219], v[236:239], v[96:99], v[216:219]
    buffer_load_dwordx4 v[84:87], v6, s[20:23], s60 offen sc1
    v_mfma_f32_16x16x32_bf16 v[220:223], v[240:243], v[96:99], v[220:223]
    v_mfma_f32_16x16x32_bf16 v[224:227], v[36:39], v[96:99], v[224:227]
    buffer_load_dwordx4 v[88:91], v7, s[20:23], s60 offen sc1
    s_add_u32 s60, s60, 1024
    s_cmp_eq_u32 s60, s61
    s_cselect_b32 s60, s59, s60
    v_mfma_f32_16x16x32_bf16 v[228:231], v[40:43], v[96:99], v[228:231]
    s_waitcnt lgkmcnt(0)
    s_waitcnt vmcnt(21)
    v_mfma_f32_16x16x32_bf16 v[152:155], v[76:79], v[100:103], v[152:155]
    buffer_load_dwordx4 v[92:95], v8, s[24:27], s57 offen offset:0 sc1
    v_mfma_f32_16x16x32_bf16 v[156:159], v[80:83], v[100:103], v[156:159]
    v_mfma_f32_16x16x32_bf16 v[160:163], v[56:59], v[100:103], v[160:163]
    buffer_load_dwordx4 v[20:23], v8, s[24:27], s57 offen offset:1024 sc1
    v_mfma_f32_16x16x32_bf16 v[164:167], v[60:63], v[100:103], v[164:167]
    v_mfma_f32_16x16x32_bf16 v[168:171], v[64:67], v[100:103], v[168:171]
    buffer_load_dwordx4 v[72:75], v8, s[24:27], s57 offen offset:2048 sc1
    s_waitcnt vmcnt(23)
    v_mfma_f32_16x16x32_bf16 v[172:175], v[76:79], v[104:107], v[172:175]
    v_mfma_f32_16x16x32_bf16 v[176:179], v[80:83], v[104:107], v[176:179]
    buffer_load_dwordx4 v[236:239], v8, s[24:27], s57 offen offset:3072 sc1
    v_mfma_f32_16x16x32_bf16 v[180:183], v[56:59], v[104:107], v[180:183]
    v_mfma_f32_16x16x32_bf16 v[184:187], v[60:63], v[104:107], v[184:187]
    buffer_load_dwordx4 v[240:243], v9, s[24:27], s57 offen offset:0 sc1
    s_add_u32 s57, s57, 5120
    s_cmp_eq_u32 s57, s58
    s_cselect_b32 s57, s56, s57
    v_mfma_f32_16x16x32_bf16 v[188:191], v[64:67], v[104:107], v[188:191]
    s_waitcnt vmcnt(24)
    v_mfma_f32_16x16x32_bf16 v[192:195], v[76:79], v[108:111], v[192:195]
    buffer_load_dwordx4 v[36:39], v4, s[20:23], s60 offen sc1
    v_mfma_f32_16x16x32_bf16 v[196:199], v[80:83], v[108:111], v[196:199]
    v_mfma_f32_16x16x32_bf16 v[200:203], v[56:59], v[108:111], v[200:203]
    buffer_load_dwordx4 v[40:43], v5, s[20:23], s60 offen sc1
    v_mfma_f32_16x16x32_bf16 v[204:207], v[60:63], v[108:111], v[204:207]
    v_mfma_f32_16x16x32_bf16 v[208:211], v[64:67], v[108:111], v[208:211]
    buffer_load_dwordx4 v[24:27], v6, s[20:23], s60 offen sc1
    s_waitcnt vmcnt(26)
    v_mfma_f32_16x16x32_bf16 v[212:215], v[76:79], v[112:115], v[212:215]
    v_mfma_f32_16x16x32_bf16 v[216:219], v[80:83], v[112:115], v[216:219]
    buffer_load_dwordx4 v[28:31], v7, s[20:23], s60 offen sc1
    s_add_u32 s60, s60, 1024
    s_cmp_eq_u32 s60, s61
    s_cselect_b32 s60, s59, s60
    v_mfma_f32_16x16x32_bf16 v[220:223], v[56:59], v[112:115], v[220:223]
    v_mfma_f32_16x16x32_bf16 v[224:227], v[60:63], v[112:115], v[224:227]
    ds_read_b32 v3, v10 offset:24
    v_mfma_f32_16x16x32_bf16 v[228:231], v[64:67], v[112:115], v[228:231]
    s_waitcnt lgkmcnt(0)
    v_readfirstlane_b32 s64, v3
    s_cmp_ge_u32 s64, 1
    s_cbranch_scc1 L_ok_16
L_cw_17:
    ds_read_b32 v3, v10 offset:24
    s_add_u32 s41, s41, 1
    s_cmp_gt_u32 s41, 400000
    s_waitcnt lgkmcnt(0)
    s_cbranch_scc1 L_cwd_18
    v_readfirstlane_b32 s64, v3
    s_cmp_ge_u32 s64, 1
    s_cbranch_scc1 L_cwd_18
    s_branch L_cw_17
L_cwd_18:
    s_mov_b32 s41, 0
L_ok_16:
    s_waitcnt vmcnt(22)
    s_waitcnt vmcnt(21)
    v_mfma_f32_16x16x32_bf16 v[152:155], v[120:123], v[144:147], v[152:155]
    buffer_load_dwordx4 v[32:35], v13, s[12:15], s51 offen
    v_mfma_f32_16x16x32_bf16 v[156:159], v[124:127], v[144:147], v[156:159]
    buffer_load_dwordx4 v[96:99], v13, s[12:15], s51 offen offset:16
    v_mfma_f32_16x16x32_bf16 v[160:163], v[128:131], v[144:147], v[160:163]
    buffer_load_dwordx2 v[76:77], v13, s[12:15], s51 offen offset:32
    v_mfma_f32_16x16x32_bf16 v[164:167], v[132:135], v[144:147], v[164:167]
    ds_read_b64_tr_b16 v[80:81], v249 offset:0
    v_mfma_f32_16x16x32_bf16 v[168:171], v[52:55], v[144:147], v[168:171]
    ds_read_b64_tr_b16 v[82:83], v249 offset:576
    s_waitcnt vmcnt(23)
    v_mfma_f32_16x16x32_bf16 v[172:175], v[120:123], v[148:151], v[172:175]
    ds_read_b64_tr_b16 v[56:57], v249 offset:1152
    v_mfma_f32_16x16x32_bf16 v[176:179], v[124:127], v[148:151], v[176:179]
    v_mfma_f32_16x16x32_bf16 v[180:183], v[128:131], v[148:151], v[180:183]
    ds_read_b64_tr_b16 v[58:59], v249 offset:1728
    v_mfma_f32_16x16x32_bf16 v[184:187], v[132:135], v[148:151], v[184:187]
    ds_read_b64_tr_b16 v[60:61], v249 offset:2304
    v_mfma_f32_16x16x32_bf16 v[188:191], v[52:55], v[148:151], v[188:191]
    s_sub_u32 s35, s39, 1
    s_and_b32 s35, s35, 3
    s_waitcnt vmcnt(22)
    v_mfma_f32_16x16x32_bf16 v[192:195], v[120:123], v[232:235], v[192:195]
    s_mul_i32 s35, s35, 20480
    s_add_u32 s35, s35, 81920
    v_mfma_f32_16x16x32_bf16 v[196:199], v[124:127], v[232:235], v[196:199]
    v_add_u32 v5, s35, v8
    v_mfma_f32_16x16x32_bf16 v[200:203], v[128:131], v[232:235], v[200:203]
    s_sub_u32 s35, s39, 2
    s_and_b32 s35, s35, 3
    v_mfma_f32_16x16x32_bf16 v[204:207], v[132:135], v[232:235], v[204:207]
    v_mfma_f32_16x16x32_bf16 v[208:211], v[52:55], v[232:235], v[208:211]
    s_mul_i32 s35, s35, 20480
    s_add_u32 s35, s35, 81920
    s_waitcnt vmcnt(21)
    v_mfma_f32_16x16x32_bf16 v[212:215], v[120:123], v[68:71], v[212:215]
    v_add_u32 v6, s35, v8
    v_mfma_f32_16x16x32_bf16 v[216:219], v[124:127], v[68:71], v[216:219]
    s_sub_u32 s35, s39, 3
    s_and_b32 s35, s35, 3
    v_mfma_f32_16x16x32_bf16 v[220:223], v[128:131], v[68:71], v[220:223]
    s_mul_i32 s35, s35, 20480
    s_add_u32 s35, s35, 81920
    v_mfma_f32_16x16x32_bf16 v[224:227], v[132:135], v[68:71], v[224:227]
    v_add_u32 v7, s35, v8
    v_mfma_f32_16x16x32_bf16 v[228:231], v[52:55], v[68:71], v[228:231]
    s_waitcnt lgkmcnt(0)
    s_waitcnt vmcnt(16)
    s_waitcnt vmcnt(15)
    v_mfma_f32_16x16x32_bf16 v[152:155], v[44:47], v[136:139], v[152:155]
    v_mfma_f32_16x16x32_bf16 v[156:159], v[48:51], v[136:139], v[156:159]
    v_lshlrev_b32 v64, 16, v80
    v_and_b32 v65, s44, v80
    v_mfma_f32_16x16x32_bf16 v[160:163], v[116:119], v[136:139], v[160:163]
    v_mfma_f32_16x16x32_bf16 v[164:167], v[244:247], v[136:139], v[164:167]
    v_lshlrev_b32 v66, 16, v81
    v_and_b32 v67, s44, v81
    v_mfma_f32_16x16x32_bf16 v[168:171], v[16:19], v[136:139], v[168:171]
    s_waitcnt vmcnt(14)
    v_mfma_f32_16x16x32_bf16 v[172:175], v[44:47], v[140:143], v[172:175]
    v_lshlrev_b32 v100, 16, v82
    v_and_b32 v101, s44, v82
    v_mfma_f32_16x16x32_bf16 v[176:179], v[48:51], v[140:143], v[176:179]
    v_mfma_f32_16x16x32_bf16 v[180:183], v[116:119], v[140:143], v[180:183]
    v_lshlrev_b32 v102, 16, v83
    v_and_b32 v103, s44, v83
    v_mfma_f32_16x16x32_bf16 v[184:187], v[244:247], v[140:143], v[184:187]
    v_mfma_f32_16x16x32_bf16 v[188:191], v[16:19], v[140:143], v[188:191]
    v_lshlrev_b32 v104, 16, v56
    v_and_b32 v105, s44, v56
    s_waitcnt vmcnt(13)
    v_mfma_f32_16x16x32_bf16 v[192:195], v[44:47], v[84:87], v[192:195]
    v_mfma_f32_16x16x32_bf16 v[196:199], v[48:51], v[84:87], v[196:199]
    v_lshlrev_b32 v106, 16, v57
    v_and_b32 v107, s44, v57
    v_mfma_f32_16x16x32_bf16 v[200:203], v[116:119], v[84:87], v[200:203]
    v_mfma_f32_16x16x32_bf16 v[204:207], v[244:247], v[84:87], v[204:207]
    v_lshlrev_b32 v108, 16, v58
    v_and_b32 v109, s44, v58
    v_mfma_f32_16x16x32_bf16 v[208:211], v[16:19], v[84:87], v[208:211]
    s_waitcnt vmcnt(12)
    v_mfma_f32_16x16x32_bf16 v[212:215], v[44:47], v[88:91], v[212:215]
    v_lshlrev_b32 v110, 16, v59
    v_and_b32 v111, s44, v59
    v_mfma_f32_16x16x32_bf16 v[216:219], v[48:51], v[88:91], v[216:219]
    v_mfma_f32_16x16x32_bf16 v[220:223], v[116:119], v[88:91], v[220:223]
    v_lshlrev_b32 v112, 16, v60
    v_and_b32 v113, s44, v60
    v_mfma_f32_16x16x32_bf16 v[224:227], v[244:247], v[88:91], v[224:227]
    v_mfma_f32_16x16x32_bf16 v[228:231], v[16:19], v[88:91], v[228:231]
    v_lshlrev_b32 v114, 16, v61
    v_and_b32 v115, s44, v61
    s_waitcnt vmcnt(0)
    v_mfma_f32_16x16x32_bf16 v[172:175], v[92:95], v[40:43], v[172:175]
    v_lshlrev_b32 v120, 16, v32
    v_and_b32 v121, s44, v32
    v_mfma_f32_16x16x32_bf16 v[176:179], v[20:23], v[40:43], v[176:179]
    v_lshlrev_b32 v122, 16, v33
    v_and_b32 v123, s44, v33
    v_mfma_f32_16x16x32_bf16 v[180:183], v[72:75], v[40:43], v[180:183]
    v_lshlrev_b32 v124, 16, v34
    v_and_b32 v125, s44, v34
    v_mfma_f32_16x16x32_bf16 v[184:187], v[236:239], v[40:43], v[184:187]
    v_lshlrev_b32 v126, 16, v35
    v_and_b32 v127, s44, v35
    v_mfma_f32_16x16x32_bf16 v[188:191], v[240:243], v[40:43], v[188:191]
    v_lshlrev_b32 v128, 16, v96
    v_and_b32 v129, s44, v96
    v_mfma_f32_16x16x32_bf16 v[192:195], v[92:95], v[24:27], v[192:195]
    v_lshlrev_b32 v130, 16, v97
    v_and_b32 v131, s44, v97
    v_mfma_f32_16x16x32_bf16 v[196:199], v[20:23], v[24:27], v[196:199]
    v_lshlrev_b32 v132, 16, v98
    v_and_b32 v133, s44, v98
    v_mfma_f32_16x16x32_bf16 v[200:203], v[72:75], v[24:27], v[200:203]
    v_lshlrev_b32 v134, 16, v99
    v_and_b32 v135, s44, v99
    v_mfma_f32_16x16x32_bf16 v[204:207], v[236:239], v[24:27], v[204:207]
    v_lshlrev_b32 v52, 16, v76
    v_and_b32 v53, s44, v76
    v_lshlrev_b32 v54, 16, v77
    v_and_b32 v55, s44, v77
    v_mfma_f32_16x16x32_bf16 v[208:211], v[240:243], v[24:27], v[208:211]
    ds_write_b128 v251, v[172:175] offset:0
    v_mfma_f32_16x16x32_bf16 v[212:215], v[92:95], v[28:31], v[212:215]
    ds_write_b128 v251, v[176:179] offset:1024
    v_mfma_f32_16x16x32_bf16 v[216:219], v[20:23], v[28:31], v[216:219]
    ds_write_b128 v251, v[180:183] offset:2048
    v_mfma_f32_16x16x32_bf16 v[220:223], v[72:75], v[28:31], v[220:223]
    ds_write_b128 v251, v[184:187] offset:3072
    v_mfma_f32_16x16x32_bf16 v[224:227], v[236:239], v[28:31], v[224:227]
    ds_write_b128 v251, v[188:191] offset:4096
    v_mfma_f32_16x16x32_bf16 v[228:231], v[240:243], v[28:31], v[228:231]
    ds_write_b128 v251, v[192:195] offset:5120
    v_mfma_f32_16x16x32_bf16 v[152:155], v[92:95], v[36:39], v[152:155]
    ds_write_b128 v251, v[196:199] offset:6144
    v_mfma_f32_16x16x32_bf16 v[156:159], v[20:23], v[36:39], v[156:159]
    ds_write_b128 v251, v[200:203] offset:7168
    v_mfma_f32_16x16x32_bf16 v[160:163], v[72:75], v[36:39], v[160:163]
    ds_write_b128 v251, v[204:207] offset:8192
    v_mfma_f32_16x16x32_bf16 v[164:167], v[236:239], v[36:39], v[164:167]
    ds_write_b128 v251, v[208:211] offset:9216
    v_mfma_f32_16x16x32_bf16 v[168:171], v[240:243], v[36:39], v[168:171]
    ds_write_b128 v251, v[212:215] offset:10240
    ds_write_b128 v251, v[216:219] offset:11264
    ds_write_b128 v251, v[220:223] offset:12288
    ds_write_b128 v251, v[224:227] offset:13312
    ds_write_b128 v251, v[228:231] offset:14336
    s_mov_b64 exec, 1
    ds_add_u32 v10, v11 offset:12
    s_mov_b64 exec, -1
    s_nop 1
    v_add_f32 v152, v152, v120
    v_add_f32 v153, v153, v121
    v_add_f32 v154, v154, v122
    v_add_f32 v155, v155, v123
    v_add_f32 v156, v156, v124
    v_add_f32 v157, v157, v125
    v_add_f32 v158, v158, v126
    v_add_f32 v159, v159, v127
    v_add_f32 v160, v160, v128
    v_add_f32 v161, v161, v129
    v_add_f32 v162, v162, v130
    v_add_f32 v163, v163, v131
    v_add_f32 v164, v164, v132
    v_add_f32 v165, v165, v133
    v_add_f32 v166, v166, v134
    v_add_f32 v167, v167, v135
    v_add_f32 v168, v168, v52
    v_add_f32 v169, v169, v53
    v_add_f32 v170, v170, v54
    v_add_f32 v171, v171, v55
L_cw_19:
    ds_read_b32 v3, v10 offset:12
    s_add_u32 s41, s41, 1
    s_cmp_gt_u32 s41, 400000
    s_waitcnt lgkmcnt(0)
    s_cbranch_scc1 L_cwd_20
    v_readfirstlane_b32 s64, v3
    s_cmp_ge_u32 s64, 4
    s_cbranch_scc1 L_cwd_20
    s_branch L_cw_19
L_cwd_20:
    s_mov_b32 s41, 0
    ds_read_b128 v[172:175], v5 offset:0
    ds_read_b128 v[192:195], v6 offset:5120
    ds_read_b128 v[212:215], v7 offset:10240
    ds_read_b128 v[176:179], v5 offset:1024
    ds_read_b128 v[196:199], v6 offset:6144
    ds_read_b128 v[216:219], v7 offset:11264
    ds_read_b128 v[180:183], v5 offset:2048
    ds_read_b128 v[200:203], v6 offset:7168
    ds_read_b128 v[220:223], v7 offset:12288
    ds_read_b128 v[184:187], v5 offset:3072
    ds_read_b128 v[204:207], v6 offset:8192
    ds_read_b128 v[224:227], v7 offset:13312
    ds_read_b128 v[188:191], v5 offset:4096
    ds_read_b128 v[208:211], v6 offset:9216
    ds_read_b128 v[228:231], v7 offset:14336
    s_waitcnt lgkmcnt(12)
    v_pk_add_f32 v[172:173], v[172:173], v[192:193]
    v_pk_add_f32 v[174:175], v[174:175], v[194:195]
    v_pk_add_f32 v[152:153], v[152:153], v[212:213]
    v_pk_add_f32 v[154:155], v[154:155], v[214:215]
    v_pk_add_f32 v[152:153], v[152:153], v[172:173]
    v_pk_add_f32 v[154:155], v[154:155], v[174:175]
    v_pk_mul_f32 v[144:145], v[152:153], s[48:49] op_sel_hi:[1,0]
    v_pk_mul_f32 v[146:147], v[154:155], s[48:49] op_sel_hi:[1,0]
    v_exp_f32 v144, v144
    v_exp_f32 v145, v145
    v_exp_f32 v146, v146
    v_exp_f32 v147, v147
    s_waitcnt lgkmcnt(9)
    v_pk_add_f32 v[176:177], v[176:177], v[196:197]
    v_pk_add_f32 v[178:179], v[178:179], v[198:199]
    v_pk_add_f32 v[156:157], v[156:157], v[216:217]
    v_pk_add_f32 v[158:159], v[158:159], v[218:219]
    v_pk_add_f32 v[156:157], v[156:157], v[176:177]
    v_pk_add_f32 v[158:159], v[158:159], v[178:179]
    v_pk_mul_f32 v[148:149], v[156:157], s[48:49] op_sel_hi:[1,0]
    v_pk_mul_f32 v[150:151], v[158:159], s[48:49] op_sel_hi:[1,0]
    v_exp_f32 v148, v148
    v_exp_f32 v149, v149
    v_exp_f32 v150, v150
    v_exp_f32 v151, v151
    s_waitcnt lgkmcnt(6)
    v_pk_add_f32 v[180:181], v[180:181], v[200:201]
    v_pk_add_f32 v[182:183], v[182:183], v[202:203]
    v_pk_add_f32 v[160:161], v[160:161], v[220:221]
    v_pk_add_f32 v[162:163], v[162:163], v[222:223]
    v_pk_add_f32 v[160:161], v[160:161], v[180:181]
    v_pk_add_f32 v[162:163], v[162:163], v[182:183]
    v_pk_mul_f32 v[232:233], v[160:161], s[48:49] op_sel_hi:[1,0]
    v_pk_mul_f32 v[234:235], v[162:163], s[48:49] op_sel_hi:[1,0]
    v_exp_f32 v232, v232
    v_exp_f32 v233, v233
    v_exp_f32 v234, v234
    v_exp_f32 v235, v235
    s_waitcnt lgkmcnt(3)
    v_pk_add_f32 v[184:185], v[184:185], v[204:205]
    v_pk_add_f32 v[186:187], v[186:187], v[206:207]
    v_pk_add_f32 v[164:165], v[164:165], v[224:225]
    v_pk_add_f32 v[166:167], v[166:167], v[226:227]
    v_pk_add_f32 v[164:165], v[164:165], v[184:185]
    v_pk_add_f32 v[166:167], v[166:167], v[186:187]
    v_pk_mul_f32 v[68:69], v[164:165], s[48:49] op_sel_hi:[1,0]
    v_pk_mul_f32 v[70:71], v[166:167], s[48:49] op_sel_hi:[1,0]
    v_exp_f32 v68, v68
    v_exp_f32 v69, v69
    v_exp_f32 v70, v70
    v_exp_f32 v71, v71
    s_waitcnt lgkmcnt(0)
    v_pk_add_f32 v[188:189], v[188:189], v[208:209]
    v_pk_add_f32 v[190:191], v[190:191], v[210:211]
    v_pk_add_f32 v[168:169], v[168:169], v[228:229]
    v_pk_add_f32 v[170:171], v[170:171], v[230:231]
    v_pk_add_f32 v[168:169], v[168:169], v[188:189]
    v_pk_add_f32 v[170:171], v[170:171], v[190:191]
    v_pk_mul_f32 v[44:45], v[168:169], s[48:49] op_sel_hi:[1,0]
    v_pk_mul_f32 v[46:47], v[170:171], s[48:49] op_sel_hi:[1,0]
    v_exp_f32 v44, v44
    v_exp_f32 v45, v45
    v_exp_f32 v46, v46
    v_exp_f32 v47, v47
    s_barrier
    ds_read_b64_tr_b16 v[140:141], v2 offset:0
    ds_read_b64_tr_b16 v[142:143], v2 offset:576
    ds_read_b64_tr_b16 v[84:85], v2 offset:1152
    ds_read_b64_tr_b16 v[86:87], v2 offset:1728
    ds_read_b64_tr_b16 v[88:89], v2 offset:2304
    v_pk_add_f32 v[144:145], v[144:145], 1.0 op_sel_hi:[1,0]
    v_pk_add_f32 v[146:147], v[146:147], 1.0 op_sel_hi:[1,0]
    v_pk_add_f32 v[148:149], v[148:149], 1.0 op_sel_hi:[1,0]
    v_pk_add_f32 v[150:151], v[150:151], 1.0 op_sel_hi:[1,0]
    v_pk_add_f32 v[232:233], v[232:233], 1.0 op_sel_hi:[1,0]
    v_pk_add_f32 v[234:235], v[234:235], 1.0 op_sel_hi:[1,0]
    v_pk_add_f32 v[68:69], v[68:69], 1.0 op_sel_hi:[1,0]
    v_pk_add_f32 v[70:71], v[70:71], 1.0 op_sel_hi:[1,0]
    v_pk_add_f32 v[44:45], v[44:45], 1.0 op_sel_hi:[1,0]
    v_pk_add_f32 v[46:47], v[46:47], 1.0 op_sel_hi:[1,0]
    v_rcp_f32 v144, v144
    v_rcp_f32 v145, v145
    v_rcp_f32 v146, v146
    v_rcp_f32 v147, v147
    v_rcp_f32 v148, v148
    v_rcp_f32 v149, v149
    v_rcp_f32 v150, v150
    v_rcp_f32 v151, v151
    s_waitcnt lgkmcnt(0)
    v_lshlrev_b32 v48, 16, v140
    v_and_b32 v49, s44, v140
    v_pk_mul_f32 v[144:145], v[144:145], v[152:153]
    v_lshlrev_b32 v50, 16, v141
    v_and_b32 v51, s44, v141
    v_pk_mul_f32 v[146:147], v[146:147], v[154:155]
    v_lshlrev_b32 v116, 16, v142
    v_and_b32 v117, s44, v142
    v_pk_mul_f32 v[148:149], v[148:149], v[156:157]
    v_lshlrev_b32 v118, 16, v143
    v_and_b32 v119, s44, v143
    v_pk_mul_f32 v[150:151], v[150:151], v[158:159]
    v_pk_fma_f32 v[64:65], v[144:145], v[48:49], v[64:65]
    v_pk_fma_f32 v[66:67], v[146:147], v[50:51], v[66:67]
    v_pk_fma_f32 v[100:101], v[148:149], v[116:117], v[100:101]
    v_pk_fma_f32 v[102:103], v[150:151], v[118:119], v[102:103]
    v_cvt_pk_bf16_f32 v92, v64, v65
    v_cvt_pk_bf16_f32 v93, v66, v67
    v_cvt_pk_bf16_f32 v94, v100, v101
    v_cvt_pk_bf16_f32 v95, v102, v103
    ds_write_b64 v15, v[92:93] offset:15360
    ds_write_b64 v15, v[94:95] offset:15368
    v_rcp_f32 v232, v232
    v_rcp_f32 v233, v233
    v_rcp_f32 v234, v234
    v_rcp_f32 v235, v235
    v_rcp_f32 v68, v68
    v_rcp_f32 v69, v69
    v_rcp_f32 v70, v70
    v_rcp_f32 v71, v71
    v_lshlrev_b32 v244, 16, v84
    v_and_b32 v245, s44, v84
    v_pk_mul_f32 v[232:233], v[232:233], v[160:161]
    v_lshlrev_b32 v246, 16, v85
    v_and_b32 v247, s44, v85
    v_pk_mul_f32 v[234:235], v[234:235], v[162:163]
    v_lshlrev_b32 v16, 16, v86
    v_and_b32 v17, s44, v86
    v_pk_mul_f32 v[68:69], v[68:69], v[164:165]
    v_lshlrev_b32 v18, 16, v87
    v_and_b32 v19, s44, v87
    v_pk_mul_f32 v[70:71], v[70:71], v[166:167]
    v_pk_fma_f32 v[104:105], v[232:233], v[244:245], v[104:105]
    v_pk_fma_f32 v[106:107], v[234:235], v[246:247], v[106:107]
    v_pk_fma_f32 v[108:109], v[68:69], v[16:17], v[108:109]
    v_pk_fma_f32 v[110:111], v[70:71], v[18:19], v[110:111]
    v_cvt_pk_bf16_f32 v20, v104, v105
    v_cvt_pk_bf16_f32 v21, v106, v107
    v_cvt_pk_bf16_f32 v22, v108, v109
    v_cvt_pk_bf16_f32 v23, v110, v111
    ds_write_b64 v15, v[20:21] offset:15376
    ds_write_b64 v15, v[22:23] offset:15384
    v_rcp_f32 v44, v44
    v_rcp_f32 v45, v45
    v_rcp_f32 v46, v46
    v_rcp_f32 v47, v47
    v_lshlrev_b32 v136, 16, v88
    v_and_b32 v137, s44, v88
    v_pk_mul_f32 v[44:45], v[44:45], v[168:169]
    v_lshlrev_b32 v138, 16, v89
    v_and_b32 v139, s44, v89
    v_pk_mul_f32 v[46:47], v[46:47], v[170:171]
    v_pk_fma_f32 v[112:113], v[44:45], v[136:137], v[112:113]
    v_pk_fma_f32 v[114:115], v[46:47], v[138:139], v[114:115]
    v_cvt_pk_bf16_f32 v72, v112, v113
    v_cvt_pk_bf16_f32 v73, v114, v115
    ds_write_b64 v15, v[72:73] offset:15392
    ds_read_b128 v[48:51], v251 offset:15360
    ds_read_b128 v[116:119], v251 offset:16384
    ds_read_b128 v[244:247], v251 offset:17408
    s_waitcnt lgkmcnt(2)
    buffer_store_dwordx4 v[48:51], v250, s[16:19], s50 offen
    s_waitcnt lgkmcnt(1)
    buffer_store_dwordx4 v[116:119], v252, s[16:19], s50 offen
    s_waitcnt lgkmcnt(0)
    s_mov_b32 exec_hi, 0
    buffer_store_dwordx4 v[244:247], v253, s[16:19], s50 offen
    s_mov_b64 exec, -1
    s_endpgm
k_s2:
    s_setprio 3
    s_branch L_poll_21_g
L_poll_21:
    s_sleep 2
L_poll_21_f:
    s_buffer_load_dwordx16 s[64:79], s[28:31], s52 glc
    s_buffer_load_dwordx16 s[84:99], s[28:31], s52 offset:64 glc
L_poll_21_g:
    s_add_u32 s41, s41, 1
    s_cmp_gt_u32 s41, 50000
    s_waitcnt lgkmcnt(0)
    s_cbranch_scc1 L_polld_22
    s_xor_b64 s[64:65], s[64:65], s[80:81]
    s_xor_b64 s[66:67], s[66:67], s[80:81]
    s_xor_b64 s[68:69], s[68:69], s[80:81]
    s_xor_b64 s[70:71], s[70:71], s[80:81]
    s_xor_b64 s[72:73], s[72:73], s[80:81]
    s_xor_b64 s[74:75], s[74:75], s[80:81]
    s_xor_b64 s[76:77], s[76:77], s[80:81]
    s_xor_b64 s[78:79], s[78:79], s[80:81]
    s_xor_b64 s[84:85], s[84:85], s[80:81]
    s_xor_b64 s[86:87], s[86:87], s[80:81]
    s_xor_b64 s[88:89], s[88:89], s[80:81]
    s_xor_b64 s[90:91], s[90:91], s[80:81]
    s_xor_b64 s[92:93], s[92:93], s[80:81]
    s_xor_b64 s[94:95], s[94:95], s[80:81]
    s_xor_b64 s[96:97], s[96:97], s[80:81]
    s_xor_b64 s[98:99], s[98:99], s[80:81]
    s_or_b64 s[64:65], s[64:65], s[66:67]
    s_or_b64 s[64:65], s[64:65], s[68:69]
    s_or_b64 s[64:65], s[64:65], s[70:71]
    s_or_b64 s[64:65], s[64:65], s[72:73]
    s_or_b64 s[64:65], s[64:65], s[74:75]
    s_or_b64 s[64:65], s[64:65], s[76:77]
    s_or_b64 s[64:65], s[64:65], s[78:79]
    s_or_b64 s[64:65], s[64:65], s[84:85]
    s_or_b64 s[64:65], s[64:65], s[86:87]
    s_or_b64 s[64:65], s[64:65], s[88:89]
    s_or_b64 s[64:65], s[64:65], s[90:91]
    s_or_b64 s[64:65], s[64:65], s[92:93]
    s_or_b64 s[64:65], s[64:65], s[94:95]
    s_or_b64 s[64:65], s[64:65], s[96:97]
    s_or_b64 s[64:65], s[64:65], s[98:99]
    s_cbranch_scc1 L_poll_21
L_polld_22:
    buffer_load_dwordx4 v[96:99], v8, s[20:23], s53 offen offset:0 sc1
    buffer_load_dwordx4 v[100:103], v8, s[20:23], s53 offen offset:1024 sc1
    buffer_load_dwordx4 v[104:107], v8, s[20:23], s53 offen offset:2048 sc1
    buffer_load_dwordx4 v[108:111], v8, s[20:23], s53 offen offset:3072 sc1
    v_cmp_eq_u32 vcc, 0, v1
    v_lshlrev_b32 v2, 16, v155
    v_cvt_pk_bf16_f32 v25, v66, v67
    v_cvt_pk_bf16_f32 v26, v68, v69
    v_cvt_pk_bf16_f32 v27, v70, v71
    v_cvt_pk_bf16_f32 v28, v72, v73
    v_cvt_pk_bf16_f32 v29, v74, v75
    v_cndmask_b32 v2, 0, v2, vcc
    ds_write_b32 v241, v26
    v_add_f32 v64, v64, v2
    ds_write_b32 v242, v27
    v_cvt_pk_bf16_f32 v24, v64, v65
    ds_write_b16 v243, v28 offset:1024
    ds_write_b16_d16_hi v243, v28 offset:1088
    ds_write_b16 v243, v29 offset:1152
    ds_write_b16_d16_hi v243, v29 offset:1216
    ds_write_b64 v240, v[24:25]
    ds_read_b64 v[16:17], v244
    ds_read_b32 v18, v244 offset:8
    ds_read2_b32 v[20:21], v245 offset0:128 offset1:129
    ds_read2_b32 v[22:23], v245 offset0:192 offset1:193
    ds_read2_b32 v[30:31], v246 offset0:128 offset1:129
    ds_write_b128 v247, v[36:39] offset:4096
    ds_write_b128 v247, v[36:39] offset:8256
    s_waitcnt lgkmcnt(2)
    v_perm_b32 v48, v17, v16, s61
    v_perm_b32 v49, v17, v16, s59
    v_perm_b32 v50, v18, v17, s60
    v_perm_b32 v51, v17, v16, s60
    v_perm_b32 v52, v21, v20, s60
    v_perm_b32 v53, v21, v20, s56
    v_perm_b32 v54, v21, v20, s58
    v_perm_b32 v55, v21, v20, s59
    ds_write_b64 v248, v[48:49] offset:2072
    ds_write_b64 v248, v[50:51] offset:6232
    v_perm_b32 v56, v23, v22, s58
    v_perm_b32 v57, v23, v22, s57
    v_perm_b32 v58, v23, v22, s59
    v_perm_b32 v59, v23, v22, s56
    v_perm_b32 v60, v23, v22, s58
    v_perm_b32 v61, v23, v22, s60
    v_perm_b32 v62, v23, v22, s57
    v_perm_b32 v63, v23, v22, s56
    s_mov_b64 exec, 1
    ds_write_b16 v7, v16 offset:8256
    s_mov_b64 exec, -1
    ds_write_b64 v248, v[52:53] offset:1560
    ds_write_b64 v248, v[54:55] offset:5720
    v_perm_b32 v64, v31, v30, s58
    v_perm_b32 v65, v31, v30, s58
    v_perm_b32 v66, v31, v30, s57
    v_perm_b32 v67, v31, v30, s57
    v_perm_b32 v68, v31, v30, s57
    v_perm_b32 v69, v31, v30, s59
    v_perm_b32 v70, v31, v30, s56
    v_perm_b32 v71, v31, v30, s56
    v_perm_b32 v72, v31, v30, s58
    v_perm_b32 v73, v31, v30, s58
    v_perm_b32 v74, v31, v30, s60
    v_perm_b32 v75, v31, v30, s57
    v_perm_b32 v76, v31, v30, s57
    v_perm_b32 v77, v31, v30, s57
    v_perm_b32 v78, v31, v30, s56
    v_perm_b32 v79, v31, v30, s56
    ds_write_b128 v249, v[56:59] offset:1040
    ds_write_b128 v249, v[60:63] offset:5200
    ds_write_b128 v250, v[64:67]
    ds_write_b128 v250, v[68:71] offset:16
    ds_write_b128 v250, v[72:75] offset:4160
    ds_write_b128 v250, v[76:79] offset:4176
    s_lshl_b32 s35, s39, 2
    v_add_u32 v47, s35, v15
L_cw_23:
    ds_read_b32 v46, v47 offset:32
    s_add_u32 s41, s41, 1
    s_cmp_gt_u32 s41, 400000
    s_waitcnt lgkmcnt(0)
    s_cbranch_scc1 L_cwd_24
    v_readfirstlane_b32 s64, v46
    s_cmp_ge_u32 s64, 1
    s_cbranch_scc1 L_cwd_24
    s_sleep 4
    s_branch L_cw_23
L_cwd_24:
    s_mov_b32 s41, 0
    ds_write_b128 v253, v[36:39]
    s_waitcnt vmcnt(3)
    ds_write_b128 v252, v[96:99] offset:480
    s_waitcnt vmcnt(2)
    ds_write_b128 v252, v[100:103] offset:1504
    s_waitcnt vmcnt(1)
    ds_write_b128 v252, v[104:107] offset:2528
    s_waitcnt vmcnt(0)
    ds_write_b128 v252, v[108:111] offset:3552
    v_mov_b32 v2, 1
    s_mov_b64 exec, 1
    ds_add_u32 v47, v2 offset:48
    s_mov_b64 exec, -1
    ds_read2_b32 v[112:113], v13 offset0:240 offset1:241
    ds_read2_b32 v[114:115], v13 offset0:242 offset1:243
    ds_read_b128 v[160:163], v9 offset:2496
    ds_read_b128 v[164:167], v9 offset:3008
    ds_read_b128 v[168:171], v9 offset:3520
    ds_read_b128 v[172:175], v9 offset:4032
    ds_read2_b32 v[116:117], v13 offset0:112 offset1:113
    ds_read2_b32 v[118:119], v13 offset0:114 offset1:115
    ds_read_b128 v[156:159], v9 offset:1984
    ds_read2_b32 v[120:121], v12 offset0:240 offset1:241
    ds_read2_b32 v[122:123], v12 offset0:242 offset1:243
    ds_read_b128 v[152:155], v9 offset:1472
    ds_read2_b32 v[124:125], v12 offset0:112 offset1:113
    ds_read2_b32 v[126:127], v12 offset0:114 offset1:115
    ds_read_b128 v[148:151], v9 offset:960
    ds_read2_b32 v[128:129], v11 offset0:240 offset1:241
    ds_read2_b32 v[130:131], v11 offset0:242 offset1:243
    ds_read_b128 v[144:147], v9 offset:448
    ds_read2_b32 v[132:133], v11 offset0:112 offset1:113
    ds_read2_b32 v[134:135], v11 offset0:114 offset1:115
    ds_read2_b32 v[136:137], v10 offset0:240 offset1:241
    ds_read2_b32 v[138:139], v10 offset0:242 offset1:243
    ds_read2_b32 v[140:141], v10 offset0:112 offset1:113
    ds_read2_b32 v[142:143], v10 offset0:114 offset1:115
    s_setprio 0
L_cw_25:
    ds_read_b32 v46, v47 offset:32
    s_add_u32 s41, s41, 1
    s_cmp_gt_u32 s41, 400000
    s_waitcnt lgkmcnt(0)
    s_cbranch_scc1 L_cwd_26
    v_readfirstlane_b32 s64, v46
    s_cmp_ge_u32 s64, 2
    s_cbranch_scc1 L_cwd_26
    s_sleep 1
    s_branch L_cw_25
L_cwd_26:
    s_mov_b32 s41, 0
    s_setprio 3
    v_mfma_f32_16x16x32_bf16 v[32:35], v[112:115], v[160:163], 0
    ds_read2_b32 v[176:177], v13 offset0:224 offset1:225
    v_mfma_f32_16x16x32_bf16 v[36:39], v[112:115], v[164:167], 0
    ds_read2_b32 v[178:179], v13 offset0:226 offset1:227
    v_mfma_f32_16x16x32_bf16 v[40:43], v[112:115], v[168:171], 0
    ds_read_b128 v[224:227], v9 offset:2432
    v_mfma_f32_16x16x32_bf16 v[44:47], v[112:115], v[172:175], 0
    ds_read_b128 v[228:231], v9 offset:2944
    v_mfma_f32_16x16x32_bf16 v[32:35], v[116:119], v[156:159], v[32:35]
    ds_read_b128 v[232:235], v9 offset:3456
    v_mfma_f32_16x16x32_bf16 v[36:39], v[116:119], v[160:163], v[36:39]
    ds_read_b128 v[236:239], v9 offset:3968
    v_mfma_f32_16x16x32_bf16 v[40:43], v[116:119], v[164:167], v[40:43]
    ds_read2_b32 v[180:181], v13 offset0:96 offset1:97
    v_mfma_f32_16x16x32_bf16 v[44:47], v[116:119], v[168:171], v[44:47]
    ds_read2_b32 v[182:183], v13 offset0:98 offset1:99
    v_mfma_f32_16x16x32_bf16 v[32:35], v[120:123], v[152:155], v[32:35]
    ds_read_b128 v[220:223], v9 offset:1920
    v_mfma_f32_16x16x32_bf16 v[36:39], v[120:123], v[156:159], v[36:39]
    ds_read2_b32 v[184:185], v12 offset0:224 offset1:225
    v_mfma_f32_16x16x32_bf16 v[40:43], v[120:123], v[160:163], v[40:43]
    ds_read2_b32 v[186:187], v12 offset0:226 offset1:227
    v_mfma_f32_16x16x32_bf16 v[44:47], v[120:123], v[164:167], v[44:47]
    ds_read_b128 v[216:219], v9 offset:1408
    v_mfma_f32_16x16x32_bf16 v[32:35], v[124:127], v[148:151], v[32:35]
    ds_read2_b32 v[188:189], v12 offset0:96 offset1:97
    v_mfma_f32_16x16x32_bf16 v[36:39], v[124:127], v[152:155], v[36:39]
    ds_read2_b32 v[190:191], v12 offset0:98 offset1:99
    v_mfma_f32_16x16x32_bf16 v[40:43], v[124:127], v[156:159], v[40:43]
    ds_read_b128 v[212:215], v9 offset:896
    v_mfma_f32_16x16x32_bf16 v[44:47], v[124:127], v[160:163], v[44:47]
    ds_read2_b32 v[192:193], v11 offset0:224 offset1:225
    v_mfma_f32_16x16x32_bf16 v[32:35], v[128:131], v[144:147], v[32:35]
    ds_read2_b32 v[194:195], v11 offset0:226 offset1:227
    v_mfma_f32_16x16x32_bf16 v[36:39], v[128:131], v[148:151], v[36:39]
    ds_read_b128 v[208:211], v9 offset:384
    v_mfma_f32_16x16x32_bf16 v[40:43], v[128:131], v[152:155], v[40:43]
    ds_read2_b32 v[196:197], v11 offset0:96 offset1:97
    v_mfma_f32_16x16x32_bf16 v[44:47], v[128:131], v[156:159], v[44:47]
    ds_read2_b32 v[198:199], v11 offset0:98 offset1:99
    v_mfma_f32_16x16x32_bf16 v[36:39], v[132:135], v[144:147], v[36:39]
    ds_read2_b32 v[200:201], v10 offset0:224 offset1:225
    v_mfma_f32_16x16x32_bf16 v[40:43], v[132:135], v[148:151], v[40:43]
    ds_read2_b32 v[202:203], v10 offset0:226 offset1:227
    v_mfma_f32_16x16x32_bf16 v[44:47], v[132:135], v[152:155], v[44:47]
    ds_read2_b32 v[204:205], v10 offset0:96 offset1:97
    v_mfma_f32_16x16x32_bf16 v[40:43], v[136:139], v[144:147], v[40:43]
    ds_read2_b32 v[206:207], v10 offset0:98 offset1:99
    v_mfma_f32_16x16x32_bf16 v[44:47], v[136:139], v[148:151], v[44:47]
    v_mfma_f32_16x16x32_bf16 v[44:47], v[140:143], v[144:147], v[44:47]
    s_waitcnt lgkmcnt(15)
    v_mfma_f32_16x16x32_bf16 v[32:35], v[176:179], v[224:227], v[32:35]
    ds_read2_b32 v[112:113], v13 offset0:208 offset1:209
    v_mfma_f32_16x16x32_bf16 v[36:39], v[176:179], v[228:231], v[36:39]
    ds_read2_b32 v[114:115], v13 offset0:210 offset1:211
    v_mfma_f32_16x16x32_bf16 v[40:43], v[176:179], v[232:235], v[40:43]
    ds_read_b128 v[160:163], v9 offset:2368
    v_mfma_f32_16x16x32_bf16 v[44:47], v[176:179], v[236:239], v[44:47]
    ds_read_b128 v[164:167], v9 offset:2880
    v_mfma_f32_16x16x32_bf16 v[32:35], v[180:183], v[220:223], v[32:35]
    ds_read_b128 v[168:171], v9 offset:3392
    v_mfma_f32_16x16x32_bf16 v[36:39], v[180:183], v[224:227], v[36:39]
    ds_read_b128 v[172:175], v9 offset:3904
    v_mfma_f32_16x16x32_bf16 v[40:43], v[180:183], v[228:231], v[40:43]
    ds_read2_b32 v[116:117], v13 offset0:80 offset1:81
    v_mfma_f32_16x16x32_bf16 v[44:47], v[180:183], v[232:235], v[44:47]
    ds_read2_b32 v[118:119], v13 offset0:82 offset1:83
    s_waitcnt lgkmcnt(15)
    v_mfma_f32_16x16x32_bf16 v[32:35], v[184:187], v[216:219], v[32:35]
    ds_read_b128 v[156:159], v9 offset:1856
    v_mfma_f32_16x16x32_bf16 v[36:39], v[184:187], v[220:223], v[36:39]
    ds_read2_b32 v[120:121], v12 offset0:208 offset1:209
    v_mfma_f32_16x16x32_bf16 v[40:43], v[184:187], v[224:227], v[40:43]
    ds_read2_b32 v[122:123], v12 offset0:210 offset1:211
    v_mfma_f32_16x16x32_bf16 v[44:47], v[184:187], v[228:231], v[44:47]
    ds_read_b128 v[152:155], v9 offset:1344
    v_mfma_f32_16x16x32_bf16 v[32:35], v[188:191], v[212:215], v[32:35]
    ds_read2_b32 v[124:125], v12 offset0:80 offset1:81
    v_mfma_f32_16x16x32_bf16 v[36:39], v[188:191], v[216:219], v[36:39]
    ds_read2_b32 v[126:127], v12 offset0:82 offset1:83
    v_mfma_f32_16x16x32_bf16 v[40:43], v[188:191], v[220:223], v[40:43]
    ds_read_b128 v[148:151], v9 offset:832
    v_mfma_f32_16x16x32_bf16 v[44:47], v[188:191], v[224:227], v[44:47]
    ds_read2_b32 v[128:129], v11 offset0:208 offset1:209
    s_waitcnt lgkmcnt(15)
    v_mfma_f32_16x16x32_bf16 v[32:35], v[192:195], v[208:211], v[32:35]
    ds_read2_b32 v[130:131], v11 offset0:210 offset1:211
    v_mfma_f32_16x16x32_bf16 v[36:39], v[192:195], v[212:215], v[36:39]
    ds_read_b128 v[144:147], v9 offset:320
    v_mfma_f32_16x16x32_bf16 v[40:43], v[192:195], v[216:219], v[40:43]
    ds_read2_b32 v[132:133], v11 offset0:80 offset1:81
    v_mfma_f32_16x16x32_bf16 v[44:47], v[192:195], v[220:223], v[44:47]
    ds_read2_b32 v[134:135], v11 offset0:82 offset1:83
    v_mfma_f32_16x16x32_bf16 v[36:39], v[196:199], v[208:211], v[36:39]
    ds_read2_b32 v[136:137], v10 offset0:208 offset1:209
    v_mfma_f32_16x16x32_bf16 v[40:43], v[196:199], v[212:215], v[40:43]
    ds_read2_b32 v[138:139], v10 offset0:210 offset1:211
    v_mfma_f32_16x16x32_bf16 v[44:47], v[196:199], v[216:219], v[44:47]
    ds_read2_b32 v[140:141], v10 offset0:80 offset1:81
    v_mfma_f32_16x16x32_bf16 v[40:43], v[200:203], v[208:211], v[40:43]
    ds_read2_b32 v[142:143], v10 offset0:82 offset1:83
    v_mfma_f32_16x16x32_bf16 v[44:47], v[200:203], v[212:215], v[44:47]
    v_mfma_f32_16x16x32_bf16 v[44:47], v[204:207], v[208:211], v[44:47]
    s_waitcnt lgkmcnt(15)
    v_mfma_f32_16x16x32_bf16 v[32:35], v[112:115], v[160:163], v[32:35]
    ds_read2_b32 v[176:177], v13 offset0:192 offset1:193
    v_mfma_f32_16x16x32_bf16 v[36:39], v[112:115], v[164:167], v[36:39]
    ds_read2_b32 v[178:179], v13 offset0:194 offset1:195
    v_mfma_f32_16x16x32_bf16 v[40:43], v[112:115], v[168:171], v[40:43]
    ds_read_b128 v[224:227], v9 offset:2304
    v_mfma_f32_16x16x32_bf16 v[44:47], v[112:115], v[172:175], v[44:47]
    ds_read_b128 v[228:231], v9 offset:2816
    v_mfma_f32_16x16x32_bf16 v[32:35], v[116:119], v[156:159], v[32:35]
    ds_read_b128 v[232:235], v9 offset:3328
    v_mfma_f32_16x16x32_bf16 v[36:39], v[116:119], v[160:163], v[36:39]
    ds_read_b128 v[236:239], v9 offset:3840
    v_mfma_f32_16x16x32_bf16 v[40:43], v[116:119], v[164:167], v[40:43]
    ds_read2_b32 v[180:181], v13 offset0:64 offset1:65
    v_mfma_f32_16x16x32_bf16 v[44:47], v[116:119], v[168:171], v[44:47]
    ds_read2_b32 v[182:183], v13 offset0:66 offset1:67
    s_waitcnt lgkmcnt(15)
    v_mfma_f32_16x16x32_bf16 v[32:35], v[120:123], v[152:155], v[32:35]
    ds_read_b128 v[220:223], v9 offset:1792
    v_mfma_f32_16x16x32_bf16 v[36:39], v[120:123], v[156:159], v[36:39]
    ds_read2_b32 v[184:185], v12 offset0:192 offset1:193
    v_mfma_f32_16x16x32_bf16 v[40:43], v[120:123], v[160:163], v[40:43]
    ds_read2_b32 v[186:187], v12 offset0:194 offset1:195
    v_mfma_f32_16x16x32_bf16 v[44:47], v[120:123], v[164:167], v[44:47]
    ds_read_b128 v[216:219], v9 offset:1280
    v_mfma_f32_16x16x32_bf16 v[32:35], v[124:127], v[148:151], v[32:35]
    ds_read2_b32 v[188:189], v12 offset0:64 offset1:65
    v_mfma_f32_16x16x32_bf16 v[36:39], v[124:127], v[152:155], v[36:39]
    ds_read2_b32 v[190:191], v12 offset0:66 offset1:67
    v_mfma_f32_16x16x32_bf16 v[40:43], v[124:127], v[156:159], v[40:43]
    ds_read_b128 v[212:215], v9 offset:768
    v_mfma_f32_16x16x32_bf16 v[44:47], v[124:127], v[160:163], v[44:47]
    ds_read2_b32 v[192:193], v11 offset0:192 offset1:193
    s_waitcnt lgkmcnt(15)
    v_mfma_f32_16x16x32_bf16 v[32:35], v[128:131], v[144:147], v[32:35]
    ds_read2_b32 v[194:195], v11 offset0:194 offset1:195
    v_mfma_f32_16x16x32_bf16 v[36:39], v[128:131], v[148:151], v[36:39]
    ds_read_b128 v[208:211], v9 offset:256
    v_mfma_f32_16x16x32_bf16 v[40:43], v[128:131], v[152:155], v[40:43]
    ds_read2_b32 v[196:197], v11 offset0:64 offset1:65
    v_mfma_f32_16x16x32_bf16 v[44:47], v[128:131], v[156:159], v[44:47]
    ds_read2_b32 v[198:199], v11 offset0:66 offset1:67
    v_mfma_f32_16x16x32_bf16 v[36:39], v[132:135], v[144:147], v[36:39]
    ds_read2_b32 v[200:201], v10 offset0:192 offset1:193
    v_mfma_f32_16x16x32_bf16 v[40:43], v[132:135], v[148:151], v[40:43]
    ds_read2_b32 v[202:203], v10 offset0:194 offset1:195
    v_mfma_f32_16x16x32_bf16 v[44:47], v[132:135], v[152:155], v[44:47]
    ds_read2_b32 v[204:205], v10 offset0:64 offset1:65
    v_mfma_f32_16x16x32_bf16 v[40:43], v[136:139], v[144:147], v[40:43]
    ds_read2_b32 v[206:207], v10 offset0:66 offset1:67
    v_mfma_f32_16x16x32_bf16 v[44:47], v[136:139], v[148:151], v[44:47]
    v_mfma_f32_16x16x32_bf16 v[44:47], v[140:143], v[144:147], v[44:47]
    s_waitcnt lgkmcnt(15)
    v_mfma_f32_16x16x32_bf16 v[32:35], v[176:179], v[224:227], v[32:35]
    ds_read2_b32 v[112:113], v13 offset0:176 offset1:177
    v_mfma_f32_16x16x32_bf16 v[36:39], v[176:179], v[228:231], v[36:39]
    ds_read2_b32 v[114:115], v13 offset0:178 offset1:179
    v_mfma_f32_16x16x32_bf16 v[40:43], v[176:179], v[232:235], v[40:43]
    ds_read_b128 v[160:163], v9 offset:2240
    v_mfma_f32_16x16x32_bf16 v[44:47], v[176:179], v[236:239], v[44:47]
    ds_read_b128 v[164:167], v9 offset:2752
    v_mfma_f32_16x16x32_bf16 v[32:35], v[180:183], v[220:223], v[32:35]
    ds_read_b128 v[168:171], v9 offset:3264
    v_mfma_f32_16x16x32_bf16 v[36:39], v[180:183], v[224:227], v[36:39]
    ds_read_b128 v[172:175], v9 offset:3776
    v_mfma_f32_16x16x32_bf16 v[40:43], v[180:183], v[228:231], v[40:43]
    ds_read2_b32 v[116:117], v13 offset0:48 offset1:49
    v_mfma_f32_16x16x32_bf16 v[44:47], v[180:183], v[232:235], v[44:47]
    ds_read2_b32 v[118:119], v13 offset0:50 offset1:51
    s_waitcnt lgkmcnt(15)
    v_mfma_f32_16x16x32_bf16 v[32:35], v[184:187], v[216:219], v[32:35]
    ds_read_b128 v[156:159], v9 offset:1728
    v_mfma_f32_16x16x32_bf16 v[36:39], v[184:187], v[220:223], v[36:39]
    ds_read2_b32 v[120:121], v12 offset0:176 offset1:177
    v_mfma_f32_16x16x32_bf16 v[40:43], v[184:187], v[224:227], v[40:43]
    ds_read2_b32 v[122:123], v12 offset0:178 offset1:179
    v_mfma_f32_16x16x32_bf16 v[44:47], v[184:187], v[228:231], v[44:47]
    ds_read_b128 v[152:155], v9 offset:1216
    v_mfma_f32_16x16x32_bf16 v[32:35], v[188:191], v[212:215], v[32:35]
    ds_read2_b32 v[124:125], v12 offset0:48 offset1:49
    v_mfma_f32_16x16x32_bf16 v[36:39], v[188:191], v[216:219], v[36:39]
    ds_read2_b32 v[126:127], v12 offset0:50 offset1:51
    v_mfma_f32_16x16x32_bf16 v[40:43], v[188:191], v[220:223], v[40:43]
    ds_read_b128 v[148:151], v9 offset:704
    v_mfma_f32_16x16x32_bf16 v[44:47], v[188:191], v[224:227], v[44:47]
    ds_read2_b32 v[128:129], v11 offset0:176 offset1:177
    s_waitcnt lgkmcnt(15)
    v_mfma_f32_16x16x32_bf16 v[32:35], v[192:195], v[208:211], v[32:35]
    ds_read2_b32 v[130:131], v11 offset0:178 offset1:179
    v_mfma_f32_16x16x32_bf16 v[36:39], v[192:195], v[212:215], v[36:39]
    ds_read_b128 v[144:147], v9 offset:192
    v_mfma_f32_16x16x32_bf16 v[40:43], v[192:195], v[216:219], v[40:43]
    ds_read2_b32 v[132:133], v11 offset0:48 offset1:49
    v_mfma_f32_16x16x32_bf16 v[44:47], v[192:195], v[220:223], v[44:47]
    ds_read2_b32 v[134:135], v11 offset0:50 offset1:51
    v_mfma_f32_16x16x32_bf16 v[36:39], v[196:199], v[208:211], v[36:39]
    ds_read2_b32 v[136:137], v10 offset0:176 offset1:177
    v_mfma_f32_16x16x32_bf16 v[40:43], v[196:199], v[212:215], v[40:43]
    ds_read2_b32 v[138:139], v10 offset0:178 offset1:179
    v_mfma_f32_16x16x32_bf16 v[44:47], v[196:199], v[216:219], v[44:47]
    ds_read2_b32 v[140:141], v10 offset0:48 offset1:49
    v_mfma_f32_16x16x32_bf16 v[40:43], v[200:203], v[208:211], v[40:43]
    ds_read2_b32 v[142:143], v10 offset0:50 offset1:51
    v_mfma_f32_16x16x32_bf16 v[44:47], v[200:203], v[212:215], v[44:47]
    v_mfma_f32_16x16x32_bf16 v[44:47], v[204:207], v[208:211], v[44:47]
    s_waitcnt lgkmcnt(15)
    v_mfma_f32_16x16x32_bf16 v[32:35], v[112:115], v[160:163], v[32:35]
    ds_read2_b32 v[176:177], v13 offset0:160 offset1:161
    v_mfma_f32_16x16x32_bf16 v[36:39], v[112:115], v[164:167], v[36:39]
    ds_read2_b32 v[178:179], v13 offset0:162 offset1:163
    v_mfma_f32_16x16x32_bf16 v[40:43], v[112:115], v[168:171], v[40:43]
    ds_read_b128 v[224:227], v9 offset:2176
    v_mfma_f32_16x16x32_bf16 v[44:47], v[112:115], v[172:175], v[44:47]
    ds_read_b128 v[228:231], v9 offset:2688
    v_mfma_f32_16x16x32_bf16 v[32:35], v[116:119], v[156:159], v[32:35]
    ds_read_b128 v[232:235], v9 offset:3200
    v_mfma_f32_16x16x32_bf16 v[36:39], v[116:119], v[160:163], v[36:39]
    ds_read_b128 v[236:239], v9 offset:3712
    v_mfma_f32_16x16x32_bf16 v[40:43], v[116:119], v[164:167], v[40:43]
    ds_read2_b32 v[180:181], v13 offset0:32 offset1:33
    v_mfma_f32_16x16x32_bf16 v[44:47], v[116:119], v[168:171], v[44:47]
    ds_read2_b32 v[182:183], v13 offset0:34 offset1:35
    s_waitcnt lgkmcnt(15)
    v_mfma_f32_16x16x32_bf16 v[32:35], v[120:123], v[152:155], v[32:35]
    ds_read_b128 v[220:223], v9 offset:1664
    v_mfma_f32_16x16x32_bf16 v[36:39], v[120:123], v[156:159], v[36:39]
    ds_read2_b32 v[184:185], v12 offset0:160 offset1:161
    v_mfma_f32_16x16x32_bf16 v[40:43], v[120:123], v[160:163], v[40:43]
    ds_read2_b32 v[186:187], v12 offset0:162 offset1:163
    v_mfma_f32_16x16x32_bf16 v[44:47], v[120:123], v[164:167], v[44:47]
    ds_read_b128 v[216:219], v9 offset:1152
    v_mfma_f32_16x16x32_bf16 v[32:35], v[124:127], v[148:151], v[32:35]
    ds_read2_b32 v[188:189], v12 offset0:32 offset1:33
    v_mfma_f32_16x16x32_bf16 v[36:39], v[124:127], v[152:155], v[36:39]
    ds_read2_b32 v[190:191], v12 offset0:34 offset1:35
    v_mfma_f32_16x16x32_bf16 v[40:43], v[124:127], v[156:159], v[40:43]
    ds_read_b128 v[212:215], v9 offset:640
    v_mfma_f32_16x16x32_bf16 v[44:47], v[124:127], v[160:163], v[44:47]
    ds_read2_b32 v[192:193], v11 offset0:160 offset1:161
    s_waitcnt lgkmcnt(15)
    v_mfma_f32_16x16x32_bf16 v[32:35], v[128:131], v[144:147], v[32:35]
    ds_read2_b32 v[194:195], v11 offset0:162 offset1:163
    v_mfma_f32_16x16x32_bf16 v[36:39], v[128:131], v[148:151], v[36:39]
    ds_read_b128 v[208:211], v9 offset:128
    v_mfma_f32_16x16x32_bf16 v[40:43], v[128:131], v[152:155], v[40:43]
    ds_read2_b32 v[196:197], v11 offset0:32 offset1:33
    v_mfma_f32_16x16x32_bf16 v[44:47], v[128:131], v[156:159], v[44:47]
    ds_read2_b32 v[198:199], v11 offset0:34 offset1:35
    v_mfma_f32_16x16x32_bf16 v[36:39], v[132:135], v[144:147], v[36:39]
    ds_read2_b32 v[200:201], v10 offset0:160 offset1:161
    v_mfma_f32_16x16x32_bf16 v[40:43], v[132:135], v[148:151], v[40:43]
    ds_read2_b32 v[202:203], v10 offset0:162 offset1:163
    v_mfma_f32_16x16x32_bf16 v[44:47], v[132:135], v[152:155], v[44:47]
    ds_read2_b32 v[204:205], v10 offset0:32 offset1:33
    v_mfma_f32_16x16x32_bf16 v[40:43], v[136:139], v[144:147], v[40:43]
    ds_read2_b32 v[206:207], v10 offset0:34 offset1:35
    v_mfma_f32_16x16x32_bf16 v[44:47], v[136:139], v[148:151], v[44:47]
    v_mfma_f32_16x16x32_bf16 v[44:47], v[140:143], v[144:147], v[44:47]
    s_waitcnt lgkmcnt(15)
    v_mfma_f32_16x16x32_bf16 v[32:35], v[176:179], v[224:227], v[32:35]
    ds_read2_b32 v[112:113], v13 offset0:144 offset1:145
    v_mfma_f32_16x16x32_bf16 v[36:39], v[176:179], v[228:231], v[36:39]
    ds_read2_b32 v[114:115], v13 offset0:146 offset1:147
    v_mfma_f32_16x16x32_bf16 v[40:43], v[176:179], v[232:235], v[40:43]
    ds_read_b128 v[160:163], v9 offset:2112
    v_mfma_f32_16x16x32_bf16 v[44:47], v[176:179], v[236:239], v[44:47]
    ds_read_b128 v[164:167], v9 offset:2624
    v_mfma_f32_16x16x32_bf16 v[32:35], v[180:183], v[220:223], v[32:35]
    ds_read_b128 v[168:171], v9 offset:3136
    v_mfma_f32_16x16x32_bf16 v[36:39], v[180:183], v[224:227], v[36:39]
    ds_read_b128 v[172:175], v9 offset:3648
    v_mfma_f32_16x16x32_bf16 v[40:43], v[180:183], v[228:231], v[40:43]
    ds_read2_b32 v[116:117], v13 offset0:16 offset1:17
    v_mfma_f32_16x16x32_bf16 v[44:47], v[180:183], v[232:235], v[44:47]
    ds_read2_b32 v[118:119], v13 offset0:18 offset1:19
    s_waitcnt lgkmcnt(15)
    v_mfma_f32_16x16x32_bf16 v[32:35], v[184:187], v[216:219], v[32:35]
    ds_read_b128 v[156:159], v9 offset:1600
    v_mfma_f32_16x16x32_bf16 v[36:39], v[184:187], v[220:223], v[36:39]
    ds_read2_b32 v[120:121], v12 offset0:144 offset1:145
    v_mfma_f32_16x16x32_bf16 v[40:43], v[184:187], v[224:227], v[40:43]
    ds_read2_b32 v[122:123], v12 offset0:146 offset1:147
    v_mfma_f32_16x16x32_bf16 v[44:47], v[184:187], v[228:231], v[44:47]
    ds_read_b128 v[152:155], v9 offset:1088
    v_mfma_f32_16x16x32_bf16 v[32:35], v[188:191], v[212:215], v[32:35]
    ds_read2_b32 v[124:125], v12 offset0:16 offset1:17
    v_mfma_f32_16x16x32_bf16 v[36:39], v[188:191], v[216:219], v[36:39]
    ds_read2_b32 v[126:127], v12 offset0:18 offset1:19
    v_mfma_f32_16x16x32_bf16 v[40:43], v[188:191], v[220:223], v[40:43]
    ds_read_b128 v[148:151], v9 offset:576
    v_mfma_f32_16x16x32_bf16 v[44:47], v[188:191], v[224:227], v[44:47]
    ds_read2_b32 v[128:129], v11 offset0:144 offset1:145
    s_waitcnt lgkmcnt(15)
    v_mfma_f32_16x16x32_bf16 v[32:35], v[192:195], v[208:211], v[32:35]
    ds_read2_b32 v[130:131], v11 offset0:146 offset1:147
    v_mfma_f32_16x16x32_bf16 v[36:39], v[192:195], v[212:215], v[36:39]
    ds_read_b128 v[144:147], v9 offset:64
    v_mfma_f32_16x16x32_bf16 v[40:43], v[192:195], v[216:219], v[40:43]
    ds_read2_b32 v[132:133], v11 offset0:16 offset1:17
    v_mfma_f32_16x16x32_bf16 v[44:47], v[192:195], v[220:223], v[44:47]
    ds_read2_b32 v[134:135], v11 offset0:18 offset1:19
    v_mfma_f32_16x16x32_bf16 v[36:39], v[196:199], v[208:211], v[36:39]
    ds_read2_b32 v[136:137], v10 offset0:144 offset1:145
    v_mfma_f32_16x16x32_bf16 v[40:43], v[196:199], v[212:215], v[40:43]
    ds_read2_b32 v[138:139], v10 offset0:146 offset1:147
    v_mfma_f32_16x16x32_bf16 v[44:47], v[196:199], v[216:219], v[44:47]
    ds_read2_b32 v[140:141], v10 offset0:16 offset1:17
    v_mfma_f32_16x16x32_bf16 v[40:43], v[200:203], v[208:211], v[40:43]
    ds_read2_b32 v[142:143], v10 offset0:18 offset1:19
    v_mfma_f32_16x16x32_bf16 v[44:47], v[200:203], v[212:215], v[44:47]
    v_mfma_f32_16x16x32_bf16 v[44:47], v[204:207], v[208:211], v[44:47]
    s_waitcnt lgkmcnt(15)
    v_mfma_f32_16x16x32_bf16 v[32:35], v[112:115], v[160:163], v[32:35]
    ds_read2_b32 v[176:177], v13 offset0:128 offset1:129
    v_mfma_f32_16x16x32_bf16 v[36:39], v[112:115], v[164:167], v[36:39]
    ds_read2_b32 v[178:179], v13 offset0:130 offset1:131
    v_mfma_f32_16x16x32_bf16 v[40:43], v[112:115], v[168:171], v[40:43]
    ds_read_b128 v[224:227], v9 offset:2048
    v_mfma_f32_16x16x32_bf16 v[44:47], v[112:115], v[172:175], v[44:47]
    ds_read_b128 v[228:231], v9 offset:2560
    v_mfma_f32_16x16x32_bf16 v[32:35], v[116:119], v[156:159], v[32:35]
    ds_read_b128 v[232:235], v9 offset:3072
    v_mfma_f32_16x16x32_bf16 v[36:39], v[116:119], v[160:163], v[36:39]
    ds_read_b128 v[236:239], v9 offset:3584
    v_mfma_f32_16x16x32_bf16 v[40:43], v[116:119], v[164:167], v[40:43]
    ds_read2_b32 v[180:181], v13 offset0:0 offset1:1
    v_mfma_f32_16x16x32_bf16 v[44:47], v[116:119], v[168:171], v[44:47]
    ds_read2_b32 v[182:183], v13 offset0:2 offset1:3
    s_waitcnt lgkmcnt(15)
    v_mfma_f32_16x16x32_bf16 v[32:35], v[120:123], v[152:155], v[32:35]
    ds_read_b128 v[220:223], v9 offset:1536
    v_mfma_f32_16x16x32_bf16 v[36:39], v[120:123], v[156:159], v[36:39]
    ds_read2_b32 v[184:185], v12 offset0:128 offset1:129
    v_mfma_f32_16x16x32_bf16 v[40:43], v[120:123], v[160:163], v[40:43]
    ds_read2_b32 v[186:187], v12 offset0:130 offset1:131
    v_mfma_f32_16x16x32_bf16 v[44:47], v[120:123], v[164:167], v[44:47]
    ds_read_b128 v[216:219], v9 offset:1024
    v_mfma_f32_16x16x32_bf16 v[32:35], v[124:127], v[148:151], v[32:35]
    ds_read2_b32 v[188:189], v12 offset0:0 offset1:1
    v_mfma_f32_16x16x32_bf16 v[36:39], v[124:127], v[152:155], v[36:39]
    ds_read2_b32 v[190:191], v12 offset0:2 offset1:3
    v_mfma_f32_16x16x32_bf16 v[40:43], v[124:127], v[156:159], v[40:43]
    ds_read_b128 v[212:215], v9 offset:512
    v_mfma_f32_16x16x32_bf16 v[44:47], v[124:127], v[160:163], v[44:47]
    ds_read2_b32 v[192:193], v11 offset0:128 offset1:129
    s_waitcnt lgkmcnt(15)
    v_mfma_f32_16x16x32_bf16 v[32:35], v[128:131], v[144:147], v[32:35]
    ds_read2_b32 v[194:195], v11 offset0:130 offset1:131
    v_mfma_f32_16x16x32_bf16 v[36:39], v[128:131], v[148:151], v[36:39]
    ds_read_b128 v[208:211], v9 offset:0
    v_mfma_f32_16x16x32_bf16 v[40:43], v[128:131], v[152:155], v[40:43]
    ds_read2_b32 v[196:197], v11 offset0:0 offset1:1
    v_mfma_f32_16x16x32_bf16 v[44:47], v[128:131], v[156:159], v[44:47]
    ds_read2_b32 v[198:199], v11 offset0:2 offset1:3
    v_mfma_f32_16x16x32_bf16 v[36:39], v[132:135], v[144:147], v[36:39]
    ds_read2_b32 v[200:201], v10 offset0:128 offset1:129
    v_mfma_f32_16x16x32_bf16 v[40:43], v[132:135], v[148:151], v[40:43]
    ds_read2_b32 v[202:203], v10 offset0:130 offset1:131
    v_mfma_f32_16x16x32_bf16 v[44:47], v[132:135], v[152:155], v[44:47]
    ds_read2_b32 v[204:205], v10 offset0:0 offset1:1
    v_mfma_f32_16x16x32_bf16 v[40:43], v[136:139], v[144:147], v[40:43]
    ds_read2_b32 v[206:207], v10 offset0:2 offset1:3
    v_mfma_f32_16x16x32_bf16 v[44:47], v[136:139], v[148:151], v[44:47]
    v_mfma_f32_16x16x32_bf16 v[44:47], v[140:143], v[144:147], v[44:47]
    s_waitcnt lgkmcnt(15)
    v_mfma_f32_16x16x32_bf16 v[32:35], v[176:179], v[224:227], v[32:35]
    v_mfma_f32_16x16x32_bf16 v[36:39], v[176:179], v[228:231], v[36:39]
    v_mfma_f32_16x16x32_bf16 v[40:43], v[176:179], v[232:235], v[40:43]
    v_mfma_f32_16x16x32_bf16 v[44:47], v[176:179], v[236:239], v[44:47]
    v_mfma_f32_16x16x32_bf16 v[32:35], v[180:183], v[220:223], v[32:35]
    v_mfma_f32_16x16x32_bf16 v[36:39], v[180:183], v[224:227], v[36:39]
    v_mfma_f32_16x16x32_bf16 v[40:43], v[180:183], v[228:231], v[40:43]
    v_mfma_f32_16x16x32_bf16 v[44:47], v[180:183], v[232:235], v[44:47]
    s_waitcnt lgkmcnt(13)
    s_waitcnt lgkmcnt(12)
    v_mfma_f32_16x16x32_bf16 v[32:35], v[184:187], v[216:219], v[32:35]
    v_mfma_f32_16x16x32_bf16 v[36:39], v[184:187], v[220:223], v[36:39]
    v_mfma_f32_16x16x32_bf16 v[40:43], v[184:187], v[224:227], v[40:43]
    v_mfma_f32_16x16x32_bf16 v[44:47], v[184:187], v[228:231], v[44:47]
    s_waitcnt lgkmcnt(10)
    s_waitcnt lgkmcnt(9)
    v_mfma_f32_16x16x32_bf16 v[32:35], v[188:191], v[212:215], v[32:35]
    v_mfma_f32_16x16x32_bf16 v[36:39], v[188:191], v[216:219], v[36:39]
    v_mfma_f32_16x16x32_bf16 v[40:43], v[188:191], v[220:223], v[40:43]
    v_mfma_f32_16x16x32_bf16 v[44:47], v[188:191], v[224:227], v[44:47]
    s_waitcnt lgkmcnt(7)
    s_waitcnt lgkmcnt(6)
    v_mfma_f32_16x16x32_bf16 v[32:35], v[192:195], v[208:211], v[32:35]
    v_mfma_f32_16x16x32_bf16 v[36:39], v[192:195], v[212:215], v[36:39]
    v_mfma_f32_16x16x32_bf16 v[40:43], v[192:195], v[216:219], v[40:43]
    v_mfma_f32_16x16x32_bf16 v[44:47], v[192:195], v[220:223], v[44:47]
    s_waitcnt lgkmcnt(4)
    v_mfma_f32_16x16x32_bf16 v[36:39], v[196:199], v[208:211], v[36:39]
    v_mfma_f32_16x16x32_bf16 v[40:43], v[196:199], v[212:215], v[40:43]
    v_mfma_f32_16x16x32_bf16 v[44:47], v[196:199], v[216:219], v[44:47]
    s_waitcnt lgkmcnt(2)
    v_mfma_f32_16x16x32_bf16 v[40:43], v[200:203], v[208:211], v[40:43]
    v_mfma_f32_16x16x32_bf16 v[44:47], v[200:203], v[212:215], v[44:47]
    s_waitcnt lgkmcnt(0)
    v_mfma_f32_16x16x32_bf16 v[44:47], v[204:207], v[208:211], v[44:47]
    s_nop 7
    v_cvt_pk_bf16_f32 v56, v32, v33
    v_cvt_pk_bf16_f32 v57, v34, v35
    v_cvt_pk_bf16_f32 v58, v36, v37
    v_cvt_pk_bf16_f32 v59, v38, v39
    v_cvt_pk_bf16_f32 v60, v40, v41
    v_cvt_pk_bf16_f32 v61, v42, v43
    v_cvt_pk_bf16_f32 v62, v44, v45
    v_cvt_pk_bf16_f32 v63, v46, v47
    v_permlane16_swap_b32 v56, v58
    v_permlane16_swap_b32 v57, v59
    buffer_store_dwordx4 v[56:59], v8, s[16:19], s53 offen offset:2048 sc1
    v_permlane16_swap_b32 v60, v62
    v_permlane16_swap_b32 v61, v63
    buffer_store_dwordx4 v[60:63], v8, s[16:19], s53 offen offset:3072 sc1
    v_mov_b32 v2, 1
    s_waitcnt vmcnt(0)
    s_mov_b64 exec, 1
    ds_add_rtn_u32 v2, v15, v2 offset:16
    s_mov_b64 exec, -1
    s_waitcnt lgkmcnt(0)
    v_readfirstlane_b32 s64, v2
    s_cmp_lg_u32 s64, s51
    s_cbranch_scc1 k_hend
    buffer_store_dword v14, v251, s[28:31], 0 offen sc1
    s_branch k_hend
k_x:
    s_setprio 1
    s_sub_u32 s37, s46, 384
    s_mov_b32 s96, s94
    s_mov_b32 s97, s95
    s_mov_b32 s98, 0x100
    s_mov_b32 s99, 0x20000
    s_cmp_lg_u32 s37, 0
    s_cbranch_scc1 k_notok
    s_memrealtime s[64:65]
    s_waitcnt lgkmcnt(0)
    s_or_b32 s64, s64, 1
    v_mov_b32 v12, s64
    s_mov_b64 exec, 1
    buffer_store_dword v12, off, s[96:99], 0 sc1
    s_mov_b64 exec, -1
k_notok:
    s_bfe_u32 s57, s37, 0x30003
    s_lshr_b32 s58, s37, 6
    s_lshl_b32 s58, s58, 3
    s_and_b32 s35, s37, 7
    s_add_u32 s58, s58, s35
    s_mul_i32 s59, s58, 40960
    s_mul_i32 s36, s57, 160
    s_add_u32 s59, s59, s36
    v_add_u32 v192, 0, v1
    v_add_u32 v196, 64, v1
    v_add_u32 v200, 128, v1
    v_add_u32 v204, 192, v1
    v_add_u32 v208, 256, v1
    v_mul_u32_u24 v193, 205, v192
    v_mul_u32_u24 v197, 205, v196
    v_mul_u32_u24 v201, 205, v200
    v_mul_u32_u24 v205, 205, v204
    v_mul_u32_u24 v209, 205, v208
    v_lshrrev_b32 v193, 11, v193
    v_lshrrev_b32 v197, 11, v197
    v_lshrrev_b32 v201, 11, v201
    v_lshrrev_b32 v205, 11, v205
    v_lshrrev_b32 v209, 11, v209
    v_mul_u32_u24 v194, 10, v193
    v_mul_u32_u24 v198, 10, v197
    v_mul_u32_u24 v202, 10, v201
    v_mul_u32_u24 v206, 10, v205
    v_mul_u32_u24 v210, 10, v209
    v_sub_u32 v194, v192, v194
    v_sub_u32 v198, v196, v198
    v_sub_u32 v202, v200, v202
    v_sub_u32 v206, v204, v206
    v_sub_u32 v210, v208, v210
    v_mul_u32_u24 v193, 1280, v193
    v_mul_u32_u24 v197, 1280, v197
    v_mul_u32_u24 v201, 1280, v201
    v_mul_u32_u24 v205, 1280, v205
    v_mul_u32_u24 v209, 1280, v209
    v_lshl_add_u32 v192, v194, 4, v193
    v_lshl_add_u32 v196, v198, 4, v197
    v_lshl_add_u32 v200, v202, 4, v201
    v_lshl_add_u32 v204, v206, 4, v205
    v_lshl_add_u32 v208, v210, 4, v209
    s_mov_b32 s12, s88
    s_mov_b32 s13, s89
    s_mov_b32 s14, 0x1e0000
    s_mov_b32 s15, 0x20000
    s_add_u32 s28, s6, 0xf00000
    s_addc_u32 s29, s7, 0
    s_mov_b32 s30, 0x40000
    s_mov_b32 s31, 0x20000
    s_add_u32 s24, s6, 0xd00000
    s_addc_u32 s25, s7, 0
    s_mov_b32 s26, 0x1e0000
    s_mov_b32 s27, 0x20000
    s_add_u32 s20, s6, 0x600000
    s_addc_u32 s21, s7, 0
    s_mov_b32 s22, 0x294000
    s_mov_b32 s23, 0x20000
    s_mul_i32 s36, s58, 43
    s_lshr_b32 s36, s36, 7
    s_lshr_b32 s55, s36, 2
    s_mul_i32 s36, s36, 3
    s_sub_u32 s36, s58, s36
    s_cmp_eq_u32 s36, 2
    s_cselect_b32 s46, 640, 0
    s_mul_i32 s47, s46, 3
    s_sub_u32 s47, 2560, s47
    v_lshrrev_b32 v12, 4, v1
    v_lshlrev_b32 v8, 4, v1
    v_mul_u32_u24 v240, 40, v1
    v_mul_u32_u24 v241, s46, v12
    v_add3_u32 v240, v240, v241, s38
    v_add_u32 v241, s47, v240
    s_lshl_b32 s56, s57, 2
    s_add_u32 s56, s56, s55
    s_lshl_b32 s56, s56, 5
    s_mul_i32 s55, s55, 12
    s_sub_u32 s55, s58, s55
    s_add_u32 s56, s56, s55
    s_lshl_b32 s56, s56, 2
    s_add_u32 s56, s56, 64
    v_lshlrev_b32 v239, 12, v1
    s_mul_i32 s57, s57, 48
    s_add_u32 s57, s57, s58
    s_mul_i32 s57, s57, 5120
    s_add_u32 s58, s57, 4096
    v_and_b32 v3, 3, v1
    v_and_b32 v2, 1, v12
    v_lshl_add_u32 v2, v2, 2, v3
    v_bfe_u32 v4, v1, 2, 2
    v_and_b32 v5, 1, v2
    v_lshl_add_u32 v4, v5, 3, v4
    v_lshrrev_b32 v5, 1, v2
    v_mul_u32_u24 v5, 20480, v5
    v_lshrrev_b32 v6, 5, v1
    v_lshl_add_u32 v5, v6, 3, v5
    v_lshl_add_u32 v5, v4, 7, v5
    v_lshrrev_b32 v4, 1, v4
    v_lshl_add_u32 v5, v4, 4, v5
    v_add_u32 v5, 81920, v5
    v_lshl_add_u32 v7, v6, 2, v3
    v_bfe_u32 v9, v1, 2, 3
    v_lshl_add_u32 v7, v7, 3, v9
    v_lshlrev_b32 v7, 4, v7
    v_add_u32 v7, s38, v7
    v_add_u32 v9, s38, v8
    v_lshrrev_b32 v10, 3, v1
    v_mul_u32_u24 v10, 4224, v10
    v_and_b32 v11, 7, v1
    v_lshl_add_u32 v10, v11, 4, v10
    v_lshlrev_b32 v6, 7, v11
    v_add_u32 v6, 31304, v6
    s_mul_i32 s46, s34, 10
    s_add_u32 s48, s46, 0
    s_and_b32 s35, s48, 7
    s_lshl_b32 s35, s35, 4
    v_xor_b32 v16, s35, v5
    s_lshr_b32 s35, s48, 3
    s_sub_i32 s35, s35, s45
    s_add_u32 s36, s35, 10
    s_cmp_lt_i32 s35, 0
    s_cselect_b32 s35, s36, s35
    s_lshl_b32 s35, s35, 11
    v_add_u32 v16, s35, v16
    v_xor_b32 v17, 32, v16
    s_add_u32 s48, s46, 1
    s_and_b32 s35, s48, 7
    s_lshl_b32 s35, s35, 4
    v_xor_b32 v18, s35, v5
    s_lshr_b32 s35, s48, 3
    s_sub_i32 s35, s35, s45
    s_add_u32 s36, s35, 10
    s_cmp_lt_i32 s35, 0
    s_cselect_b32 s35, s36, s35
    s_lshl_b32 s35, s35, 11
    v_add_u32 v18, s35, v18
    v_xor_b32 v19, 32, v18
    s_add_u32 s48, s46, 2
    s_and_b32 s35, s48, 7
    s_lshl_b32 s35, s35, 4
    v_xor_b32 v20, s35, v5
    s_lshr_b32 s35, s48, 3
    s_sub_i32 s35, s35, s45
    s_add_u32 s36, s35, 10
    s_cmp_lt_i32 s35, 0
    s_cselect_b32 s35, s36, s35
    s_lshl_b32 s35, s35, 11
    v_add_u32 v20, s35, v20
    v_xor_b32 v21, 32, v20
    s_add_u32 s48, s46, 3
    s_and_b32 s35, s48, 7
    s_lshl_b32 s35, s35, 4
    v_xor_b32 v22, s35, v5
    s_lshr_b32 s35, s48, 3
    s_sub_i32 s35, s35, s45
    s_add_u32 s36, s35, 10
    s_cmp_lt_i32 s35, 0
    s_cselect_b32 s35, s36, s35
    s_lshl_b32 s35, s35, 11
    v_add_u32 v22, s35, v22
    v_xor_b32 v23, 32, v22
    s_add_u32 s48, s46, 4
    s_and_b32 s35, s48, 7
    s_lshl_b32 s35, s35, 4
    v_xor_b32 v24, s35, v5
    s_lshr_b32 s35, s48, 3
    s_sub_i32 s35, s35, s45
    s_add_u32 s36, s35, 10
    s_cmp_lt_i32 s35, 0
    s_cselect_b32 s35, s36, s35
    s_lshl_b32 s35, s35, 11
    v_add_u32 v24, s35, v24
    v_xor_b32 v25, 32, v24
    s_add_u32 s48, s46, 5
    s_and_b32 s35, s48, 7
    s_lshl_b32 s35, s35, 4
    v_xor_b32 v26, s35, v5
    s_lshr_b32 s35, s48, 3
    s_sub_i32 s35, s35, s45
    s_add_u32 s36, s35, 10
    s_cmp_lt_i32 s35, 0
    s_cselect_b32 s35, s36, s35
    s_lshl_b32 s35, s35, 11
    v_add_u32 v26, s35, v26
    v_xor_b32 v27, 32, v26
    s_add_u32 s48, s46, 6
    s_and_b32 s35, s48, 7
    s_lshl_b32 s35, s35, 4
    v_xor_b32 v28, s35, v5
    s_lshr_b32 s35, s48, 3
    s_sub_i32 s35, s35, s45
    s_add_u32 s36, s35, 10
    s_cmp_lt_i32 s35, 0
    s_cselect_b32 s35, s36, s35
    s_lshl_b32 s35, s35, 11
    v_add_u32 v28, s35, v28
    v_xor_b32 v29, 32, v28
    s_add_u32 s48, s46, 7
    s_and_b32 s35, s48, 7
    s_lshl_b32 s35, s35, 4
    v_xor_b32 v30, s35, v5
    s_lshr_b32 s35, s48, 3
    s_sub_i32 s35, s35, s45
    s_add_u32 s36, s35, 10
    s_cmp_lt_i32 s35, 0
    s_cselect_b32 s35, s36, s35
    s_lshl_b32 s35, s35, 11
    v_add_u32 v30, s35, v30
    v_xor_b32 v31, 32, v30
    s_add_u32 s48, s46, 8
    s_and_b32 s35, s48, 7
    s_lshl_b32 s35, s35, 4
    v_xor_b32 v32, s35, v5
    s_lshr_b32 s35, s48, 3
    s_sub_i32 s35, s35, s45
    s_add_u32 s36, s35, 10
    s_cmp_lt_i32 s35, 0
    s_cselect_b32 s35, s36, s35
    s_lshl_b32 s35, s35, 11
    v_add_u32 v32, s35, v32
    v_xor_b32 v33, 32, v32
    s_add_u32 s48, s46, 9
    s_and_b32 s35, s48, 7
    s_lshl_b32 s35, s35, 4
    v_xor_b32 v34, s35, v5
    s_lshr_b32 s35, s48, 3
    s_sub_i32 s35, s35, s45
    s_add_u32 s36, s35, 10
    s_cmp_lt_i32 s35, 0
    s_cselect_b32 s35, s36, s35
    s_lshl_b32 s35, s35, 11
    v_add_u32 v34, s35, v34
    v_xor_b32 v35, 32, v34
    s_mul_i32 s52, s34, 1747680
    s_lshr_b32 s52, s52, 16
    s_lshl_b32 s52, s52, 1
    s_and_b32 s53, s34, 1
    s_add_u32 s52, s52, s53
    s_lshl_b32 s52, s52, 5
    s_add_u32 s52, s52, s33
    s_lshl_b32 s52, s52, 2
    s_add_u32 s52, s52, 135168
    v_lshlrev_b32 v242, 8, v1
    s_mul_i32 s46, s46, 33792
    s_lshl_b32 s36, s33, 7
    s_add_u32 s46, s46, s36
    v_mov_b32 v13, 1
    s_lshl_b32 s51, s33, 3
    s_add_u32 s51, s51, s34
    s_lshl_b32 s51, s51, 7
    s_add_u32 s51, s51, 229376
    s_sub_u32 s60, s51, 229376
    s_lshl_b32 s60, s60, 2
    s_buffer_load_dword s66, s[28:31], s60 offset:0 glc
    s_buffer_load_dword s67, s[28:31], s60 offset:128 glc
    s_buffer_load_dword s68, s[28:31], s60 offset:256 glc
    s_buffer_load_dword s69, s[28:31], s60 offset:384 glc
    s_lshl_b32 s61, s2, 8
    s_buffer_load_dword s70, s[28:31], s61 offset:135168 glc
    s_buffer_load_dword s71, s[28:31], s61 offset:135296 glc
    s_buffer_load_dword s72, s[28:31], s51 glc
    buffer_load_dword v14, off, s[96:99], 0 sc1
    s_cmp_lg_u32 s39, 3
    s_cbranch_scc1 k_x2
L_cw_27:
    ds_read_b32 v2, v15 offset:0
    s_add_u32 s41, s41, 1
    s_cmp_gt_u32 s41, 400000
    s_waitcnt lgkmcnt(0)
    s_cbranch_scc1 L_cwd_28
    v_readfirstlane_b32 s64, v2
    s_cmp_ge_u32 s64, 4
    s_cbranch_scc1 L_cwd_28
    s_sleep 1
    s_branch L_cw_27
L_cwd_28:
    s_mov_b32 s41, 0
    ds_read_b64_tr_b16 v[40:41], v16
    ds_read_b64_tr_b16 v[42:43], v17 offset:512
    ds_read_b64_tr_b16 v[44:45], v18
    ds_read_b64_tr_b16 v[46:47], v19 offset:512
    ds_read_b64_tr_b16 v[48:49], v20
    ds_read_b64_tr_b16 v[50:51], v21 offset:512
    ds_read_b64_tr_b16 v[52:53], v22
    ds_read_b64_tr_b16 v[54:55], v23 offset:512
    ds_read_b64_tr_b16 v[56:57], v24
    ds_read_b64_tr_b16 v[58:59], v25 offset:512
    ds_read_b64_tr_b16 v[60:61], v26
    ds_read_b64_tr_b16 v[62:63], v27 offset:512
    ds_read_b64_tr_b16 v[64:65], v28
    ds_read_b64_tr_b16 v[66:67], v29 offset:512
    ds_read_b64_tr_b16 v[68:69], v30
    ds_read_b64_tr_b16 v[70:71], v31 offset:512
    ds_read_b64_tr_b16 v[72:73], v32
    ds_read_b64_tr_b16 v[74:75], v33 offset:512
    ds_read_b64_tr_b16 v[76:77], v34
    ds_read_b64_tr_b16 v[78:79], v35 offset:512
    s_mov_b64 exec, 1
    ds_add_u32 v15, v13 offset:8
    s_mov_b64 exec, -1
k_x2:
    buffer_load_dwordx4 v[216:219], v192, s[12:15], s59 offen
    buffer_load_dwordx4 v[220:223], v196, s[12:15], s59 offen
    buffer_load_dwordx4 v[224:227], v200, s[12:15], s59 offen
    buffer_load_dwordx4 v[228:231], v204, s[12:15], s59 offen
    buffer_load_dwordx4 v[232:235], v208, s[12:15], s59 offen
    s_cmp_lg_u32 s39, 3
    s_cbranch_scc1 k_x3
    s_waitcnt lgkmcnt(15)
    ds_write_b128 v7, v[40:43] offset:0
    ds_read_b128 v[80:83], v9 offset:0
    ds_write_b128 v7, v[44:47] offset:1024
    ds_read_b128 v[84:87], v9 offset:1024
    ds_write_b128 v7, v[48:51] offset:2048
    ds_read_b128 v[88:91], v9 offset:2048
    s_waitcnt lgkmcnt(15)
    ds_write_b128 v7, v[52:55] offset:3072
    ds_read_b128 v[92:95], v9 offset:3072
    ds_write_b128 v7, v[56:59] offset:4096
    ds_read_b128 v[96:99], v9 offset:4096
    ds_write_b128 v7, v[60:63] offset:0
    ds_read_b128 v[100:103], v9 offset:0
    s_waitcnt lgkmcnt(15)
    ds_write_b128 v7, v[64:67] offset:1024
    ds_read_b128 v[104:107], v9 offset:1024
    ds_write_b128 v7, v[68:71] offset:2048
    ds_read_b128 v[108:111], v9 offset:2048
    ds_write_b128 v7, v[72:75] offset:3072
    ds_read_b128 v[112:115], v9 offset:3072
    s_waitcnt lgkmcnt(15)
    ds_write_b128 v7, v[76:79] offset:4096
    ds_read_b128 v[116:119], v9 offset:4096
k_x3:
    s_waitcnt vmcnt(0) lgkmcnt(0)
    ds_write_b128 v9, v[216:219] offset:0
    ds_write_b128 v9, v[220:223] offset:1024
    ds_write_b128 v9, v[224:227] offset:2048
    ds_write_b128 v9, v[228:231] offset:3072
    ds_write_b128 v9, v[232:235] offset:4096
    ds_read_b64_tr_b16 v[16:17], v240 offset:0
    ds_read_b64_tr_b16 v[18:19], v241 offset:0
    ds_read_b64_tr_b16 v[20:21], v240 offset:8
    ds_read_b64_tr_b16 v[22:23], v241 offset:8
    ds_read_b64_tr_b16 v[24:25], v240 offset:16
    ds_read_b64_tr_b16 v[26:27], v241 offset:16
    ds_read_b64_tr_b16 v[28:29], v240 offset:24
    ds_read_b64_tr_b16 v[30:31], v241 offset:24
    ds_read_b64_tr_b16 v[32:33], v240 offset:32
    ds_read_b64_tr_b16 v[34:35], v241 offset:32
L_tok_29:
    v_readfirstlane_b32 s80, v14
    s_add_u32 s41, s41, 1
    s_cmp_lg_u32 s80, 0
    s_cbranch_scc1 L_tokd_30
    s_cmp_gt_u32 s41, 50000
    s_cbranch_scc1 L_tokd_30
    s_sleep 2
    buffer_load_dword v14, off, s[96:99], 0 sc1
    s_waitcnt vmcnt(0)
    s_branch L_tok_29
L_tokd_30:
    s_mov_b32 s81, s80
    s_waitcnt lgkmcnt(0)
    buffer_store_dwordx4 v[16:19], v8, s[24:27], s57 offen offset:0 sc1
    buffer_store_dwordx4 v[20:23], v8, s[24:27], s57 offen offset:1024 sc1
    buffer_store_dwordx4 v[24:27], v8, s[24:27], s57 offen offset:2048 sc1
    buffer_store_dwordx4 v[28:31], v8, s[24:27], s57 offen offset:3072 sc1
    buffer_store_dwordx4 v[32:35], v8, s[24:27], s58 offen sc1
    s_cmp_lg_u32 s39, 3
    s_cbranch_scc1 k_x4
L_cw_31:
    ds_read_b32 v2, v15 offset:20
    s_add_u32 s41, s41, 1
    s_cmp_gt_u32 s41, 400000
    s_waitcnt lgkmcnt(0)
    s_cbranch_scc1 L_cwd_32
    v_readfirstlane_b32 s64, v2
    s_cmp_ge_u32 s64, 4
    s_cbranch_scc1 L_cwd_32
    s_sleep 1
    s_branch L_cw_31
L_cwd_32:
    s_mov_b32 s41, 0
    ds_read_b64 v[120:121], v6 offset:0
    ds_read_b64 v[122:123], v6 offset:16
    ds_read_b64 v[124:125], v6 offset:32
    ds_read_b64 v[126:127], v6 offset:48
    ds_read_b64 v[128:129], v6 offset:64
    ds_read_b64 v[130:131], v6 offset:80
    ds_read_b64 v[132:133], v6 offset:96
    ds_read_b64 v[134:135], v6 offset:112
    v_lshlrev_b32 v136, 16, v80
    v_and_b32 v137, s44, v80
    v_lshlrev_b32 v138, 16, v81
    v_and_b32 v139, s44, v81
    v_lshlrev_b32 v140, 16, v82
    v_and_b32 v141, s44, v82
    v_lshlrev_b32 v142, 16, v83
    v_and_b32 v143, s44, v83
    v_lshlrev_b32 v144, 16, v84
    v_and_b32 v145, s44, v84
    v_lshlrev_b32 v146, 16, v85
    v_and_b32 v147, s44, v85
    v_lshlrev_b32 v148, 16, v86
    v_and_b32 v149, s44, v86
    v_lshlrev_b32 v150, 16, v87
    v_and_b32 v151, s44, v87
    v_lshlrev_b32 v152, 16, v88
    v_and_b32 v153, s44, v88
    v_lshlrev_b32 v154, 16, v89
    v_and_b32 v155, s44, v89
    v_lshlrev_b32 v156, 16, v90
    v_and_b32 v157, s44, v90
    v_lshlrev_b32 v158, 16, v91
    v_and_b32 v159, s44, v91
    v_lshlrev_b32 v160, 16, v92
    v_and_b32 v161, s44, v92
    v_lshlrev_b32 v162, 16, v93
    v_and_b32 v163, s44, v93
    v_lshlrev_b32 v164, 16, v94
    v_and_b32 v165, s44, v94
    v_lshlrev_b32 v166, 16, v95
    v_and_b32 v167, s44, v95
    v_lshlrev_b32 v168, 16, v96
    v_and_b32 v169, s44, v96
    v_lshlrev_b32 v170, 16, v97
    v_and_b32 v171, s44, v97
    v_lshlrev_b32 v172, 16, v98
    v_and_b32 v173, s44, v98
    v_lshlrev_b32 v174, 16, v99
    v_and_b32 v175, s44, v99
    v_lshlrev_b32 v176, 16, v100
    v_and_b32 v177, s44, v100
    v_lshlrev_b32 v178, 16, v101
    v_and_b32 v179, s44, v101
    v_lshlrev_b32 v180, 16, v102
    v_and_b32 v181, s44, v102
    v_lshlrev_b32 v182, 16, v103
    v_and_b32 v183, s44, v103
    v_lshlrev_b32 v184, 16, v104
    v_and_b32 v185, s44, v104
    v_lshlrev_b32 v186, 16, v105
    v_and_b32 v187, s44, v105
    v_lshlrev_b32 v188, 16, v106
    v_and_b32 v189, s44, v106
    v_lshlrev_b32 v190, 16, v107
    v_and_b32 v191, s44, v107
    v_lshlrev_b32 v192, 16, v108
    v_and_b32 v193, s44, v108
    v_lshlrev_b32 v194, 16, v109
    v_and_b32 v195, s44, v109
    v_lshlrev_b32 v196, 16, v110
    v_and_b32 v197, s44, v110
    v_lshlrev_b32 v198, 16, v111
    v_and_b32 v199, s44, v111
    v_lshlrev_b32 v200, 16, v112
    v_and_b32 v201, s44, v112
    v_lshlrev_b32 v202, 16, v113
    v_and_b32 v203, s44, v113
    v_lshlrev_b32 v204, 16, v114
    v_and_b32 v205, s44, v114
    v_lshlrev_b32 v206, 16, v115
    v_and_b32 v207, s44, v115
    v_lshlrev_b32 v208, 16, v116
    v_and_b32 v209, s44, v116
    v_lshlrev_b32 v210, 16, v117
    v_and_b32 v211, s44, v117
    v_lshlrev_b32 v212, 16, v118
    v_and_b32 v213, s44, v118
    v_lshlrev_b32 v214, 16, v119
    v_and_b32 v215, s44, v119
    s_waitcnt lgkmcnt(0)
    v_fma_f32 v136, v136, v120, v121
    v_fma_f32 v137, v137, v122, v123
    v_fma_f32 v138, v138, v124, v125
    v_fma_f32 v139, v139, v126, v127
    v_fma_f32 v140, v140, v128, v129
    v_fma_f32 v141, v141, v130, v131
    v_fma_f32 v142, v142, v132, v133
    v_fma_f32 v143, v143, v134, v135
    v_cvt_pk_bf16_f32 v40, v136, v137
    v_cvt_pk_bf16_f32 v41, v138, v139
    v_cvt_pk_bf16_f32 v42, v140, v141
    v_cvt_pk_bf16_f32 v43, v142, v143
    v_fma_f32 v144, v144, v120, v121
    v_fma_f32 v145, v145, v122, v123
    v_fma_f32 v146, v146, v124, v125
    v_fma_f32 v147, v147, v126, v127
    v_fma_f32 v148, v148, v128, v129
    v_fma_f32 v149, v149, v130, v131
    v_fma_f32 v150, v150, v132, v133
    v_fma_f32 v151, v151, v134, v135
    v_cvt_pk_bf16_f32 v44, v144, v145
    v_cvt_pk_bf16_f32 v45, v146, v147
    v_cvt_pk_bf16_f32 v46, v148, v149
    v_cvt_pk_bf16_f32 v47, v150, v151
    v_fma_f32 v152, v152, v120, v121
    v_fma_f32 v153, v153, v122, v123
    v_fma_f32 v154, v154, v124, v125
    v_fma_f32 v155, v155, v126, v127
    v_fma_f32 v156, v156, v128, v129
    v_fma_f32 v157, v157, v130, v131
    v_fma_f32 v158, v158, v132, v133
    v_fma_f32 v159, v159, v134, v135
    v_cvt_pk_bf16_f32 v48, v152, v153
    v_cvt_pk_bf16_f32 v49, v154, v155
    v_cvt_pk_bf16_f32 v50, v156, v157
    v_cvt_pk_bf16_f32 v51, v158, v159
    v_fma_f32 v160, v160, v120, v121
    v_fma_f32 v161, v161, v122, v123
    v_fma_f32 v162, v162, v124, v125
    v_fma_f32 v163, v163, v126, v127
    v_fma_f32 v164, v164, v128, v129
    v_fma_f32 v165, v165, v130, v131
    v_fma_f32 v166, v166, v132, v133
    v_fma_f32 v167, v167, v134, v135
    v_cvt_pk_bf16_f32 v52, v160, v161
    v_cvt_pk_bf16_f32 v53, v162, v163
    v_cvt_pk_bf16_f32 v54, v164, v165
    v_cvt_pk_bf16_f32 v55, v166, v167
    v_fma_f32 v168, v168, v120, v121
    v_fma_f32 v169, v169, v122, v123
    v_fma_f32 v170, v170, v124, v125
    v_fma_f32 v171, v171, v126, v127
    v_fma_f32 v172, v172, v128, v129
    v_fma_f32 v173, v173, v130, v131
    v_fma_f32 v174, v174, v132, v133
    v_fma_f32 v175, v175, v134, v135
    v_cvt_pk_bf16_f32 v56, v168, v169
    v_cvt_pk_bf16_f32 v57, v170, v171
    v_cvt_pk_bf16_f32 v58, v172, v173
    v_cvt_pk_bf16_f32 v59, v174, v175
k_x4:
    s_waitcnt vmcnt(0)
    s_mov_b32 exec_hi, 0
    buffer_store_dword v14, v239, s[28:31], s56 offen sc1
    s_mov_b64 exec, -1
    s_cmp_lg_u32 s39, 3
    s_cbranch_scc1 k_hend
    v_fma_f32 v176, v176, v120, v121
    v_fma_f32 v177, v177, v122, v123
    v_fma_f32 v178, v178, v124, v125
    v_fma_f32 v179, v179, v126, v127
    v_fma_f32 v180, v180, v128, v129
    v_fma_f32 v181, v181, v130, v131
    v_fma_f32 v182, v182, v132, v133
    v_fma_f32 v183, v183, v134, v135
    v_cvt_pk_bf16_f32 v60, v176, v177
    v_cvt_pk_bf16_f32 v61, v178, v179
    v_cvt_pk_bf16_f32 v62, v180, v181
    v_cvt_pk_bf16_f32 v63, v182, v183
    v_fma_f32 v184, v184, v120, v121
    v_fma_f32 v185, v185, v122, v123
    v_fma_f32 v186, v186, v124, v125
    v_fma_f32 v187, v187, v126, v127
    v_fma_f32 v188, v188, v128, v129
    v_fma_f32 v189, v189, v130, v131
    v_fma_f32 v190, v190, v132, v133
    v_fma_f32 v191, v191, v134, v135
    v_cvt_pk_bf16_f32 v64, v184, v185
    v_cvt_pk_bf16_f32 v65, v186, v187
    v_cvt_pk_bf16_f32 v66, v188, v189
    v_cvt_pk_bf16_f32 v67, v190, v191
    v_fma_f32 v192, v192, v120, v121
    v_fma_f32 v193, v193, v122, v123
    v_fma_f32 v194, v194, v124, v125
    v_fma_f32 v195, v195, v126, v127
    v_fma_f32 v196, v196, v128, v129
    v_fma_f32 v197, v197, v130, v131
    v_fma_f32 v198, v198, v132, v133
    v_fma_f32 v199, v199, v134, v135
    v_cvt_pk_bf16_f32 v68, v192, v193
    v_cvt_pk_bf16_f32 v69, v194, v195
    v_cvt_pk_bf16_f32 v70, v196, v197
    v_cvt_pk_bf16_f32 v71, v198, v199
    v_fma_f32 v200, v200, v120, v121
    v_fma_f32 v201, v201, v122, v123
    v_fma_f32 v202, v202, v124, v125
    v_fma_f32 v203, v203, v126, v127
    v_fma_f32 v204, v204, v128, v129
    v_fma_f32 v205, v205, v130, v131
    v_fma_f32 v206, v206, v132, v133
    v_fma_f32 v207, v207, v134, v135
    v_cvt_pk_bf16_f32 v72, v200, v201
    v_cvt_pk_bf16_f32 v73, v202, v203
    v_cvt_pk_bf16_f32 v74, v204, v205
    v_cvt_pk_bf16_f32 v75, v206, v207
    v_fma_f32 v208, v208, v120, v121
    v_fma_f32 v209, v209, v122, v123
    v_fma_f32 v210, v210, v124, v125
    v_fma_f32 v211, v211, v126, v127
    v_fma_f32 v212, v212, v128, v129
    v_fma_f32 v213, v213, v130, v131
    v_fma_f32 v214, v214, v132, v133
    v_fma_f32 v215, v215, v134, v135
    v_cvt_pk_bf16_f32 v76, v208, v209
    v_cvt_pk_bf16_f32 v77, v210, v211
    v_cvt_pk_bf16_f32 v78, v212, v213
    v_cvt_pk_bf16_f32 v79, v214, v215
    buffer_store_dwordx4 v[40:43], v10, s[20:23], s46 offen sc1
    s_add_u32 s46, s46, 33792
    buffer_store_dwordx4 v[44:47], v10, s[20:23], s46 offen sc1
    s_add_u32 s46, s46, 33792
    buffer_store_dwordx4 v[48:51], v10, s[20:23], s46 offen sc1
    s_add_u32 s46, s46, 33792
    buffer_store_dwordx4 v[52:55], v10, s[20:23], s46 offen sc1
    s_add_u32 s46, s46, 33792
    buffer_store_dwordx4 v[56:59], v10, s[20:23], s46 offen sc1
    s_add_u32 s46, s46, 33792
    buffer_store_dwordx4 v[60:63], v10, s[20:23], s46 offen sc1
    s_add_u32 s46, s46, 33792
    buffer_store_dwordx4 v[64:67], v10, s[20:23], s46 offen sc1
    s_add_u32 s46, s46, 33792
    buffer_store_dwordx4 v[68:71], v10, s[20:23], s46 offen sc1
    s_add_u32 s46, s46, 33792
    buffer_store_dwordx4 v[72:75], v10, s[20:23], s46 offen sc1
    s_add_u32 s46, s46, 33792
    buffer_store_dwordx4 v[76:79], v10, s[20:23], s46 offen sc1
    s_add_u32 s46, s46, 33792
    s_waitcnt vmcnt(0)
    s_mov_b64 exec, 0xfffffff
    buffer_store_dword v14, v242, s[28:31], s52 offen sc1
    s_mov_b64 exec, -1
    s_add_u32 s16, s6, 0xa00000
    s_addc_u32 s17, s7, 0
    s_mov_b32 s18, 0x294000
    s_mov_b32 s19, 0x20000
    v_lshrrev_b32 v3, 3, v1
    v_bfe_u32 v4, v1, 2, 1
    v_and_b32 v5, 3, v1
    v_mul_u32_u24 v6, 4224, v3
    v_lshl_add_u32 v6, v4, 9, v6
    v_lshl_add_u32 v6, v5, 4, v6
    v_mul_u32_u24 v7, 144, v3
    v_lshl_add_u32 v7, v5, 5, v7
    v_lshl_add_u32 v7, v4, 4, v7
    v_add_u32 v7, 69632, v7
    s_mul_i32 s50, s34, 337920
    s_lshr_b32 s51, s33, 3
    s_lshl_b32 s51, s51, 10
    s_add_u32 s50, s50, s51
    s_and_b32 s51, s33, 7
    s_lshl_b32 s51, s51, 6
    s_add_u32 s50, s50, s51
    s_lshl_b32 s51, s33, 3
    s_add_u32 s51, s51, s34
    s_lshl_b32 s51, s51, 7
    s_add_u32 s51, s51, 229376
    v_mul_u32_u24 v9, 144, v3
    v_lshl_add_u32 v9, v11, 4, v9
L_cw_33:
    ds_read_b32 v2, v15 offset:8
    s_add_u32 s41, s41, 1
    s_cmp_gt_u32 s41, 400000
    s_waitcnt lgkmcnt(0)
    s_cbranch_scc1 L_cwd_34
    v_readfirstlane_b32 s64, v2
    s_cmp_ge_u32 s64, 5
    s_cbranch_scc1 L_cwd_34
    s_sleep 8
    s_branch L_cw_33
L_cwd_34:
    s_mov_b32 s41, 0
    ds_write_b128 v9, v[80:83] offset:37376
    ds_write_b128 v9, v[84:87] offset:38528
    ds_write_b128 v9, v[88:91] offset:39680
    ds_write_b128 v9, v[92:95] offset:40832
    ds_write_b128 v9, v[96:99] offset:41984
    ds_write_b128 v9, v[100:103] offset:49664
    ds_write_b128 v9, v[104:107] offset:50816
    ds_write_b128 v9, v[108:111] offset:51968
    ds_write_b128 v9, v[112:115] offset:53120
    ds_write_b128 v9, v[116:119] offset:54272
    s_mov_b64 exec, 1
    ds_add_u32 v15, v13 offset:24
    s_mov_b64 exec, -1
    s_cmp_ge_u32 s2, 214
    s_cbranch_scc1 k_xpoll
    s_mov_b32 s83, 229376
    s_mul_i32 s56, s2, 3
    s_add_u32 s56, s56, 0
    s_min_u32 s56, s56, 639
    s_mul_i32 s56, s56, 205
    s_lshr_b32 s56, s56, 14
    s_mul_i32 s58, s56, 1747680
    s_lshr_b32 s58, s58, 16
    s_sub_u32 s58, s2, s58
    s_lshl_b32 s56, s56, 5
    s_add_u32 s56, s56, s58
    s_lshl_b32 s56, s56, 2
    s_mul_i32 s57, s2, 3
    s_add_u32 s57, s57, 2
    s_min_u32 s57, s57, 639
    s_mul_i32 s57, s57, 205
    s_lshr_b32 s57, s57, 14
    s_mul_i32 s58, s57, 1747680
    s_lshr_b32 s58, s58, 16
    s_sub_u32 s58, s2, s58
    s_lshl_b32 s57, s57, 5
    s_add_u32 s57, s57, s58
    s_lshl_b32 s57, s57, 2
    v_cmp_gt_u32 vcc, 32, v1
    v_and_b32 v243, 31, v1
    v_lshlrev_b32 v243, 10, v243
    v_mov_b32 v2, s56
    v_mov_b32 v3, s57
    v_cndmask_b32 v2, v3, v2, vcc
    v_add3_u32 v243, v243, v2, s83
    s_cmp_eq_u32 s2, 213
    s_cselect_b32 s57, 1, 3
    v_and_b32 v4, 15, v1
    v_lshrrev_b32 v5, 4, v1
    v_lshlrev_b32 v2, 3, v5
    v_sub_u32 v2, v2, v4
    v_add_u32 v2, 15, v2
    v_and_b32 v3, 1, v2
    v_mul_u32_u24 v3, 4162, v3
    v_lshl_add_u32 v2, v2, 1, v3
    v_add_u32 v244, 0, v2
    v_add_u32 v245, 1024, v244
    v_add_u32 v246, 2048, v244
    v_add_u32 v247, 3072, v244
    v_lshlrev_b32 v248, 5, v4
    v_lshl_add_u32 v248, v5, 4, v248
    v_add_u32 v248, 32768, v248
    s_mul_i32 s58, s2, 12672
    s_mov_b32 s59, 0
    v_mov_b32 v249, v15
L_cw_35:
    ds_read_b32 v2, v15 offset:44
    s_add_u32 s41, s41, 1
    s_cmp_gt_u32 s41, 400000
    s_waitcnt lgkmcnt(0)
    s_cbranch_scc1 L_cwd_36
    v_readfirstlane_b32 s64, v2
    s_cmp_ge_u32 s64, 2
    s_cbranch_scc1 L_cwd_36
    s_sleep 2
    s_branch L_cw_35
L_cwd_36:
    s_mov_b32 s41, 0
L_cw_37:
    ds_read_b32 v2, v249 offset:48
    s_add_u32 s41, s41, 1
    s_cmp_gt_u32 s41, 400000
    s_waitcnt lgkmcnt(0)
    s_cbranch_scc1 L_cwd_38
    v_readfirstlane_b32 s64, v2
    s_cmp_ge_u32 s64, 1
    s_cbranch_scc1 L_cwd_38
    s_branch L_cw_37
L_cwd_38:
    s_mov_b32 s41, 0
    s_setprio 3
    ds_read2_b32 v[112:113], v247 offset0:240 offset1:241
    ds_read2_b32 v[114:115], v247 offset0:242 offset1:243
    ds_read_b128 v[128:131], v248 offset:448
    ds_read_b128 v[132:135], v248 offset:960
    ds_read_b128 v[136:139], v248 offset:1472
    ds_read_b128 v[140:143], v248 offset:1984
    ds_read2_b32 v[116:117], v247 offset0:112 offset1:113
    ds_read2_b32 v[118:119], v247 offset0:114 offset1:115
    ds_read2_b32 v[120:121], v246 offset0:240 offset1:241
    ds_read2_b32 v[122:123], v246 offset0:242 offset1:243
    ds_read2_b32 v[124:125], v246 offset0:112 offset1:113
    ds_read2_b32 v[126:127], v246 offset0:114 offset1:115
    ds_read2_b32 v[144:145], v247 offset0:224 offset1:225
    ds_read2_b32 v[146:147], v247 offset0:226 offset1:227
    ds_read_b128 v[160:163], v248 offset:384
    ds_read_b128 v[164:167], v248 offset:896
    ds_read_b128 v[168:171], v248 offset:1408
    ds_read_b128 v[172:175], v248 offset:1920
    ds_read2_b32 v[148:149], v247 offset0:96 offset1:97
    ds_read2_b32 v[150:151], v247 offset0:98 offset1:99
    ds_read2_b32 v[152:153], v246 offset0:224 offset1:225
    ds_read2_b32 v[154:155], v246 offset0:226 offset1:227
    ds_read2_b32 v[156:157], v246 offset0:96 offset1:97
    ds_read2_b32 v[158:159], v246 offset0:98 offset1:99
k_xconv:
    s_waitcnt lgkmcnt(12)
    v_mfma_f32_16x16x32_bf16 v[16:19], v[112:115], v[128:131], 0
    ds_read2_b32 v[176:177], v247 offset0:208 offset1:209
    ds_read2_b32 v[178:179], v247 offset0:210 offset1:211
    v_mfma_f32_16x16x32_bf16 v[20:23], v[112:115], v[132:135], 0
    ds_read_b128 v[192:195], v248 offset:320
    ds_read_b128 v[196:199], v248 offset:832
    v_mfma_f32_16x16x32_bf16 v[24:27], v[112:115], v[136:139], 0
    ds_read_b128 v[200:203], v248 offset:1344
    v_mfma_f32_16x16x32_bf16 v[28:31], v[112:115], v[140:143], 0
    ds_read_b128 v[204:207], v248 offset:1856
    v_mfma_f32_16x16x32_bf16 v[20:23], v[116:119], v[128:131], v[20:23]
    ds_read2_b32 v[180:181], v247 offset0:80 offset1:81
    v_mfma_f32_16x16x32_bf16 v[24:27], v[116:119], v[132:135], v[24:27]
    ds_read2_b32 v[182:183], v247 offset0:82 offset1:83
    v_mfma_f32_16x16x32_bf16 v[28:31], v[116:119], v[136:139], v[28:31]
    ds_read2_b32 v[184:185], v246 offset0:208 offset1:209
    v_mfma_f32_16x16x32_bf16 v[24:27], v[120:123], v[128:131], v[24:27]
    ds_read2_b32 v[186:187], v246 offset0:210 offset1:211
    v_mfma_f32_16x16x32_bf16 v[28:31], v[120:123], v[132:135], v[28:31]
    ds_read2_b32 v[188:189], v246 offset0:80 offset1:81
    v_mfma_f32_16x16x32_bf16 v[28:31], v[124:127], v[128:131], v[28:31]
    ds_read2_b32 v[190:191], v246 offset0:82 offset1:83
    s_waitcnt lgkmcnt(12)
    v_mfma_f32_16x16x32_bf16 v[16:19], v[144:147], v[160:163], v[16:19]
    ds_read2_b32 v[208:209], v247 offset0:192 offset1:193
    ds_read2_b32 v[210:211], v247 offset0:194 offset1:195
    v_mfma_f32_16x16x32_bf16 v[20:23], v[144:147], v[164:167], v[20:23]
    ds_read_b128 v[224:227], v248 offset:256
    ds_read_b128 v[228:231], v248 offset:768
    v_mfma_f32_16x16x32_bf16 v[24:27], v[144:147], v[168:171], v[24:27]
    ds_read_b128 v[232:235], v248 offset:1280
    v_mfma_f32_16x16x32_bf16 v[28:31], v[144:147], v[172:175], v[28:31]
    ds_read_b128 v[236:239], v248 offset:1792
    v_mfma_f32_16x16x32_bf16 v[20:23], v[148:151], v[160:163], v[20:23]
    ds_read2_b32 v[212:213], v247 offset0:64 offset1:65
    v_mfma_f32_16x16x32_bf16 v[24:27], v[148:151], v[164:167], v[24:27]
    ds_read2_b32 v[214:215], v247 offset0:66 offset1:67
    v_mfma_f32_16x16x32_bf16 v[28:31], v[148:151], v[168:171], v[28:31]
    ds_read2_b32 v[216:217], v246 offset0:192 offset1:193
    v_mfma_f32_16x16x32_bf16 v[24:27], v[152:155], v[160:163], v[24:27]
    ds_read2_b32 v[218:219], v246 offset0:194 offset1:195
    v_mfma_f32_16x16x32_bf16 v[28:31], v[152:155], v[164:167], v[28:31]
    ds_read2_b32 v[220:221], v246 offset0:64 offset1:65
    v_mfma_f32_16x16x32_bf16 v[28:31], v[156:159], v[160:163], v[28:31]
    ds_read2_b32 v[222:223], v246 offset0:66 offset1:67
    s_waitcnt lgkmcnt(12)
    v_mfma_f32_16x16x32_bf16 v[16:19], v[176:179], v[192:195], v[16:19]
    ds_read2_b32 v[112:113], v247 offset0:176 offset1:177
    ds_read2_b32 v[114:115], v247 offset0:178 offset1:179
    v_mfma_f32_16x16x32_bf16 v[20:23], v[176:179], v[196:199], v[20:23]
    ds_read_b128 v[128:131], v248 offset:192
    ds_read_b128 v[132:135], v248 offset:704
    v_mfma_f32_16x16x32_bf16 v[24:27], v[176:179], v[200:203], v[24:27]
    ds_read_b128 v[136:139], v248 offset:1216
    v_mfma_f32_16x16x32_bf16 v[28:31], v[176:179], v[204:207], v[28:31]
    ds_read_b128 v[140:143], v248 offset:1728
    v_mfma_f32_16x16x32_bf16 v[20:23], v[180:183], v[192:195], v[20:23]
    ds_read2_b32 v[116:117], v247 offset0:48 offset1:49
    v_mfma_f32_16x16x32_bf16 v[24:27], v[180:183], v[196:199], v[24:27]
    ds_read2_b32 v[118:119], v247 offset0:50 offset1:51
    v_mfma_f32_16x16x32_bf16 v[28:31], v[180:183], v[200:203], v[28:31]
    ds_read2_b32 v[120:121], v246 offset0:176 offset1:177
    v_mfma_f32_16x16x32_bf16 v[24:27], v[184:187], v[192:195], v[24:27]
    ds_read2_b32 v[122:123], v246 offset0:178 offset1:179
    v_mfma_f32_16x16x32_bf16 v[28:31], v[184:187], v[196:199], v[28:31]
    ds_read2_b32 v[124:125], v246 offset0:48 offset1:49
    v_mfma_f32_16x16x32_bf16 v[28:31], v[188:191], v[192:195], v[28:31]
    ds_read2_b32 v[126:127], v246 offset0:50 offset1:51
    s_waitcnt lgkmcnt(12)
    v_mfma_f32_16x16x32_bf16 v[16:19], v[208:211], v[224:227], v[16:19]
    ds_read2_b32 v[144:145], v247 offset0:160 offset1:161
    ds_read2_b32 v[146:147], v247 offset0:162 offset1:163
    v_mfma_f32_16x16x32_bf16 v[20:23], v[208:211], v[228:231], v[20:23]
    ds_read_b128 v[160:163], v248 offset:128
    ds_read_b128 v[164:167], v248 offset:640
    v_mfma_f32_16x16x32_bf16 v[24:27], v[208:211], v[232:235], v[24:27]
    ds_read_b128 v[168:171], v248 offset:1152
    v_mfma_f32_16x16x32_bf16 v[28:31], v[208:211], v[236:239], v[28:31]
    ds_read_b128 v[172:175], v248 offset:1664
    v_mfma_f32_16x16x32_bf16 v[20:23], v[212:215], v[224:227], v[20:23]
    ds_read2_b32 v[148:149], v247 offset0:32 offset1:33
    v_mfma_f32_16x16x32_bf16 v[24:27], v[212:215], v[228:231], v[24:27]
    ds_read2_b32 v[150:151], v247 offset0:34 offset1:35
    v_mfma_f32_16x16x32_bf16 v[28:31], v[212:215], v[232:235], v[28:31]
    ds_read2_b32 v[152:153], v246 offset0:160 offset1:161
    v_mfma_f32_16x16x32_bf16 v[24:27], v[216:219], v[224:227], v[24:27]
    ds_read2_b32 v[154:155], v246 offset0:162 offset1:163
    v_mfma_f32_16x16x32_bf16 v[28:31], v[216:219], v[228:231], v[28:31]
    ds_read2_b32 v[156:157], v246 offset0:32 offset1:33
    v_mfma_f32_16x16x32_bf16 v[28:31], v[220:223], v[224:227], v[28:31]
    ds_read2_b32 v[158:159], v246 offset0:34 offset1:35
    ds_read_b32 v250, v249 offset:52
    s_waitcnt lgkmcnt(13)
    v_mfma_f32_16x16x32_bf16 v[16:19], v[112:115], v[128:131], v[16:19]
    ds_read2_b32 v[176:177], v247 offset0:144 offset1:145
    ds_read2_b32 v[178:179], v247 offset0:146 offset1:147
    v_mfma_f32_16x16x32_bf16 v[20:23], v[112:115], v[132:135], v[20:23]
    ds_read_b128 v[192:195], v248 offset:64
    ds_read_b128 v[196:199], v248 offset:576
    v_mfma_f32_16x16x32_bf16 v[24:27], v[112:115], v[136:139], v[24:27]
    ds_read_b128 v[200:203], v248 offset:1088
    v_mfma_f32_16x16x32_bf16 v[28:31], v[112:115], v[140:143], v[28:31]
    ds_read_b128 v[204:207], v248 offset:1600
    v_mfma_f32_16x16x32_bf16 v[20:23], v[116:119], v[128:131], v[20:23]
    ds_read2_b32 v[180:181], v247 offset0:16 offset1:17
    v_mfma_f32_16x16x32_bf16 v[24:27], v[116:119], v[132:135], v[24:27]
    ds_read2_b32 v[182:183], v247 offset0:18 offset1:19
    v_mfma_f32_16x16x32_bf16 v[28:31], v[116:119], v[136:139], v[28:31]
    ds_read2_b32 v[184:185], v246 offset0:144 offset1:145
    v_mfma_f32_16x16x32_bf16 v[24:27], v[120:123], v[128:131], v[24:27]
    ds_read2_b32 v[186:187], v246 offset0:146 offset1:147
    v_mfma_f32_16x16x32_bf16 v[28:31], v[120:123], v[132:135], v[28:31]
    ds_read2_b32 v[188:189], v246 offset0:16 offset1:17
    v_mfma_f32_16x16x32_bf16 v[28:31], v[124:127], v[128:131], v[28:31]
    ds_read2_b32 v[190:191], v246 offset0:18 offset1:19
    s_waitcnt lgkmcnt(13)
    v_mfma_f32_16x16x32_bf16 v[16:19], v[144:147], v[160:163], v[16:19]
    ds_read2_b32 v[208:209], v247 offset0:128 offset1:129
    ds_read2_b32 v[210:211], v247 offset0:130 offset1:131
    v_mfma_f32_16x16x32_bf16 v[20:23], v[144:147], v[164:167], v[20:23]
    ds_read_b128 v[224:227], v248 offset:0
    ds_read_b128 v[228:231], v248 offset:512
    v_mfma_f32_16x16x32_bf16 v[24:27], v[144:147], v[168:171], v[24:27]
    ds_read_b128 v[232:235], v248 offset:1024
    v_mfma_f32_16x16x32_bf16 v[28:31], v[144:147], v[172:175], v[28:31]
    ds_read_b128 v[236:239], v248 offset:1536
    v_mfma_f32_16x16x32_bf16 v[20:23], v[148:151], v[160:163], v[20:23]
    ds_read2_b32 v[212:213], v247 offset0:0 offset1:1
    v_mfma_f32_16x16x32_bf16 v[24:27], v[148:151], v[164:167], v[24:27]
    ds_read2_b32 v[214:215], v247 offset0:2 offset1:3
    v_mfma_f32_16x16x32_bf16 v[28:31], v[148:151], v[168:171], v[28:31]
    ds_read2_b32 v[216:217], v246 offset0:128 offset1:129
    v_mfma_f32_16x16x32_bf16 v[24:27], v[152:155], v[160:163], v[24:27]
    ds_read2_b32 v[218:219], v246 offset0:130 offset1:131
    v_mfma_f32_16x16x32_bf16 v[28:31], v[152:155], v[164:167], v[28:31]
    ds_read2_b32 v[220:221], v246 offset0:0 offset1:1
    v_mfma_f32_16x16x32_bf16 v[28:31], v[156:159], v[160:163], v[28:31]
    ds_read2_b32 v[222:223], v246 offset0:2 offset1:3
    s_add_u32 s59, s59, 1
    v_add_u32 v249, 4, v249
    s_cmp_ge_u32 s59, s57
    s_cbranch_scc1 k_xnw
    s_waitcnt lgkmcnt(15)
    v_readfirstlane_b32 s64, v250
    s_cmp_ge_u32 s64, 1
    s_cbranch_scc1 L_ok_39
L_cw_40:
    ds_read_b32 v250, v249 offset:48
    s_add_u32 s41, s41, 1
    s_cmp_gt_u32 s41, 400000
    s_waitcnt lgkmcnt(0)
    s_cbranch_scc1 L_cwd_41
    v_readfirstlane_b32 s64, v250
    s_cmp_ge_u32 s64, 1
    s_cbranch_scc1 L_cwd_41
    s_branch L_cw_40
L_cwd_41:
    s_mov_b32 s41, 0
L_ok_39:
k_xnw:
    v_add_u32 v246, 8704, v246
    v_add_u32 v247, 8704, v247
    v_add_u32 v248, 12288, v248
    s_waitcnt lgkmcnt(12)
    v_mfma_f32_16x16x32_bf16 v[16:19], v[176:179], v[192:195], v[16:19]
    ds_read2_b32 v[112:113], v247 offset0:240 offset1:241
    ds_read2_b32 v[114:115], v247 offset0:242 offset1:243
    v_mfma_f32_16x16x32_bf16 v[20:23], v[176:179], v[196:199], v[20:23]
    ds_read_b128 v[128:131], v248 offset:448
    ds_read_b128 v[132:135], v248 offset:960
    v_mfma_f32_16x16x32_bf16 v[24:27], v[176:179], v[200:203], v[24:27]
    ds_read_b128 v[136:139], v248 offset:1472
    v_mfma_f32_16x16x32_bf16 v[28:31], v[176:179], v[204:207], v[28:31]
    ds_read_b128 v[140:143], v248 offset:1984
    v_mfma_f32_16x16x32_bf16 v[20:23], v[180:183], v[192:195], v[20:23]
    ds_read2_b32 v[116:117], v247 offset0:112 offset1:113
    v_mfma_f32_16x16x32_bf16 v[24:27], v[180:183], v[196:199], v[24:27]
    ds_read2_b32 v[118:119], v247 offset0:114 offset1:115
    v_mfma_f32_16x16x32_bf16 v[28:31], v[180:183], v[200:203], v[28:31]
    ds_read2_b32 v[120:121], v246 offset0:240 offset1:241
    v_mfma_f32_16x16x32_bf16 v[24:27], v[184:187], v[192:195], v[24:27]
    ds_read2_b32 v[122:123], v246 offset0:242 offset1:243
    v_mfma_f32_16x16x32_bf16 v[28:31], v[184:187], v[196:199], v[28:31]
    ds_read2_b32 v[124:125], v246 offset0:112 offset1:113
    v_mfma_f32_16x16x32_bf16 v[28:31], v[188:191], v[192:195], v[28:31]
    ds_read2_b32 v[126:127], v246 offset0:114 offset1:115
    s_waitcnt lgkmcnt(12)
    v_mfma_f32_16x16x32_bf16 v[16:19], v[208:211], v[224:227], v[16:19]
    ds_read2_b32 v[144:145], v247 offset0:224 offset1:225
    ds_read2_b32 v[146:147], v247 offset0:226 offset1:227
    v_mfma_f32_16x16x32_bf16 v[20:23], v[208:211], v[228:231], v[20:23]
    ds_read_b128 v[160:163], v248 offset:384
    ds_read_b128 v[164:167], v248 offset:896
    v_mfma_f32_16x16x32_bf16 v[24:27], v[208:211], v[232:235], v[24:27]
    ds_read_b128 v[168:171], v248 offset:1408
    v_mfma_f32_16x16x32_bf16 v[28:31], v[208:211], v[236:239], v[28:31]
    ds_read_b128 v[172:175], v248 offset:1920
    v_mfma_f32_16x16x32_bf16 v[20:23], v[212:215], v[224:227], v[20:23]
    ds_read2_b32 v[148:149], v247 offset0:96 offset1:97
    v_mfma_f32_16x16x32_bf16 v[24:27], v[212:215], v[228:231], v[24:27]
    ds_read2_b32 v[150:151], v247 offset0:98 offset1:99
    v_mfma_f32_16x16x32_bf16 v[28:31], v[212:215], v[232:235], v[28:31]
    ds_read2_b32 v[152:153], v246 offset0:224 offset1:225
    v_mfma_f32_16x16x32_bf16 v[24:27], v[216:219], v[224:227], v[24:27]
    ds_read2_b32 v[154:155], v246 offset0:226 offset1:227
    v_mfma_f32_16x16x32_bf16 v[28:31], v[216:219], v[228:231], v[28:31]
    ds_read2_b32 v[156:157], v246 offset0:96 offset1:97
    v_mfma_f32_16x16x32_bf16 v[28:31], v[220:223], v[224:227], v[28:31]
    ds_read2_b32 v[158:159], v246 offset0:98 offset1:99
    s_nop 7
    v_cvt_pk_bf16_f32 v48, v16, v17
    v_cvt_pk_bf16_f32 v49, v18, v19
    v_cvt_pk_bf16_f32 v50, v20, v21
    v_cvt_pk_bf16_f32 v51, v22, v23
    v_cvt_pk_bf16_f32 v52, v24, v25
    v_cvt_pk_bf16_f32 v53, v26, v27
    v_cvt_pk_bf16_f32 v54, v28, v29
    v_cvt_pk_bf16_f32 v55, v30, v31
    v_permlane16_swap_b32 v48, v50
    v_permlane16_swap_b32 v49, v51
    buffer_store_dwordx4 v[48:51], v8, s[16:19], s58 offen offset:0 sc1
    v_permlane16_swap_b32 v52, v54
    v_permlane16_swap_b32 v53, v55
    buffer_store_dwordx4 v[52:55], v8, s[16:19], s58 offen offset:1024 sc1
    s_add_u32 s58, s58, 4224
    s_cmp_lt_u32 s59, s57
    s_cbranch_scc1 k_xconv
    v_mov_b32 v2, 1
    s_waitcnt vmcnt(0)
    s_mov_b64 exec, 1
    ds_add_rtn_u32 v2, v15, v2 offset:16
    s_mov_b64 exec, -1
    s_waitcnt lgkmcnt(0)
    v_readfirstlane_b32 s64, v2
    s_cmp_lg_u32 s64, s57
    s_cbranch_scc1 k_xpoll
    buffer_store_dword v14, v243, s[28:31], 0 offen sc1
k_xpoll:
    s_setprio 0
    s_lshr_b32 s52, 0x92, s34
    s_branch L_poll_42_f
L_poll_42:
    s_sleep 2
L_poll_42_f:
    s_buffer_load_dwordx16 s[64:79], s[28:31], s51 glc
    s_buffer_load_dwordx16 s[84:99], s[28:31], s51 offset:64 glc
L_poll_42_g:
    s_add_u32 s41, s41, 1
    s_cmp_gt_u32 s41, 50000
    s_waitcnt lgkmcnt(0)
    s_cbranch_scc1 L_polld_43
    s_bitcmp1_b32 s52, 0
    s_cselect_b32 s95, s95, s80
    s_xor_b64 s[64:65], s[64:65], s[80:81]
    s_xor_b64 s[66:67], s[66:67], s[80:81]
    s_xor_b64 s[68:69], s[68:69], s[80:81]
    s_xor_b64 s[70:71], s[70:71], s[80:81]
    s_xor_b64 s[72:73], s[72:73], s[80:81]
    s_xor_b64 s[74:75], s[74:75], s[80:81]
    s_xor_b64 s[76:77], s[76:77], s[80:81]
    s_xor_b64 s[78:79], s[78:79], s[80:81]
    s_xor_b64 s[84:85], s[84:85], s[80:81]
    s_xor_b64 s[86:87], s[86:87], s[80:81]
    s_xor_b64 s[88:89], s[88:89], s[80:81]
    s_xor_b64 s[90:91], s[90:91], s[80:81]
    s_xor_b64 s[92:93], s[92:93], s[80:81]
    s_xor_b64 s[94:95], s[94:95], s[80:81]
    s_or_b64 s[64:65], s[64:65], s[66:67]
    s_or_b64 s[64:65], s[64:65], s[68:69]
    s_or_b64 s[64:65], s[64:65], s[70:71]
    s_or_b64 s[64:65], s[64:65], s[72:73]
    s_or_b64 s[64:65], s[64:65], s[74:75]
    s_or_b64 s[64:65], s[64:65], s[76:77]
    s_or_b64 s[64:65], s[64:65], s[78:79]
    s_or_b64 s[64:65], s[64:65], s[84:85]
    s_or_b64 s[64:65], s[64:65], s[86:87]
    s_or_b64 s[64:65], s[64:65], s[88:89]
    s_or_b64 s[64:65], s[64:65], s[90:91]
    s_or_b64 s[64:65], s[64:65], s[92:93]
    s_or_b64 s[64:65], s[64:65], s[94:95]
    s_cbranch_scc1 L_poll_42
L_polld_43:
    buffer_load_dwordx4 v[16:19], v6, s[16:19], s50 offen sc1
    s_add_u32 s50, s50, 33792
    buffer_load_dwordx4 v[20:23], v6, s[16:19], s50 offen sc1
    s_add_u32 s50, s50, 33792
    buffer_load_dwordx4 v[24:27], v6, s[16:19], s50 offen sc1
    s_add_u32 s50, s50, 33792
    buffer_load_dwordx4 v[28:31], v6, s[16:19], s50 offen sc1
    s_add_u32 s50, s50, 33792
    buffer_load_dwordx4 v[32:35], v6, s[16:19], s50 offen sc1
    s_add_u32 s50, s50, 33792
    buffer_load_dwordx4 v[36:39], v6, s[16:19], s50 offen sc1
    s_add_u32 s50, s50, 33792
    buffer_load_dwordx4 v[40:43], v6, s[16:19], s50 offen sc1
    s_add_u32 s50, s50, 33792
    buffer_load_dwordx4 v[44:47], v6, s[16:19], s50 offen sc1
    s_add_u32 s50, s50, 33792
    buffer_load_dwordx4 v[48:51], v6, s[16:19], s50 offen sc1
    s_add_u32 s50, s50, 33792
    buffer_load_dwordx4 v[52:55], v6, s[16:19], s50 offen sc1
    s_add_u32 s50, s50, 33792
    s_waitcnt vmcnt(9)
    ds_write_b128 v7, v[16:19] offset:0
    s_waitcnt vmcnt(8)
    ds_write_b128 v7, v[20:23] offset:1152
    s_waitcnt vmcnt(7)
    ds_write_b128 v7, v[24:27] offset:2304
    s_waitcnt vmcnt(6)
    ds_write_b128 v7, v[28:31] offset:3456
    s_waitcnt vmcnt(5)
    ds_write_b128 v7, v[32:35] offset:4608
    s_waitcnt vmcnt(4)
    ds_write_b128 v7, v[36:39] offset:5760
    s_waitcnt vmcnt(3)
    ds_write_b128 v7, v[40:43] offset:6912
    s_waitcnt vmcnt(2)
    ds_write_b128 v7, v[44:47] offset:8064
    s_waitcnt vmcnt(1)
    ds_write_b128 v7, v[48:51] offset:9216
    s_waitcnt vmcnt(0)
    ds_write_b128 v7, v[52:55] offset:10368
    s_waitcnt lgkmcnt(0)
k_hend:
k_end:
    s_endpgm
code_end:
.section .rodata,"a"
.p2align 6
.amdhsa_kernel recurrent_scan__ssm_conv_s4__dense_activation_gelu__prompt_kernel
  .amdhsa_next_free_vgpr 256
  .amdhsa_next_free_sgpr 102
  .amdhsa_accum_offset 256
  .amdhsa_group_segment_fixed_size 0
  .amdhsa_kernarg_size 136
  .amdhsa_user_sgpr_count 2
  .amdhsa_user_sgpr_kernarg_segment_ptr 1
  .amdhsa_system_sgpr_workgroup_id_x 1
.end_amdhsa_kernel
```
